```python
import torch

def _softmax(x, axis=-1):
    return torch.softmax(x, dim=axis)
def _gelu(x):
    return torch.nn.functional.gelu(x, approximate="tanh")
def _silu(x):
    return torch.nn.functional.silu(x)
def _sigmoid(x):
    return torch.sigmoid(x)
def _layernorm(x, axis=-1, eps=1e-5):
    m = x.mean(dim=axis, keepdim=True)
    v = x.var(dim=axis, keepdim=True, unbiased=False)
    return (x - m) / torch.sqrt(v + eps)
def _scatter_add(tgt, idx, src, axis=0):
    return tgt.clone().index_add_(axis, idx, src)
def _segment_sum(src, seg, n):
    out = torch.zeros((n,) + src.shape[1:], dtype=src.dtype)
    return out.index_add_(0, seg, src)
def _pad(x, pw):
    flat = tuple(v for pair in reversed(pw) for v in pair)
    return torch.nn.functional.pad(x, flat)

kernel_name = 'gated_mix__ssm_conv_s4d__geglu_ffn__prompt'

def setup_inputs():

    _w = (lambda a: (lambda t: t.to(torch.bfloat16) if t.is_floating_point() else t)(torch.as_tensor(a)))
    def _A_setup():
        Bsz, L, D, N = 1, 2048, 512, 128
        return {
            "u": _w((lambda *s: torch.randn(*s, dtype=torch.bfloat16) * 0.05)(Bsz, L, D)),
            "log_A_real": _w((lambda *s: torch.randn(*s, dtype=torch.bfloat16) * 6.4)(D, N) * 0.5),
            "A_imag": _w((lambda *s: torch.randn(*s, dtype=torch.bfloat16) * 0.05)(D, N) * 3.14),
            "C_real": _w((lambda *s: torch.randn(*s, dtype=torch.bfloat16) * 0.05)(D, N) / N ** 0.5),
            "C_imag": _w((lambda *s: torch.randn(*s, dtype=torch.bfloat16) * 0.05)(D, N) / N ** 0.5),
            "log_dt": _w((lambda *s: torch.randn(*s, dtype=torch.bfloat16) * 0.05)(D) * 0.5 - 4.0),
            "D_skip": _w((lambda *s: torch.randn(*s, dtype=torch.bfloat16) * 0.05)(D)),
        }
    _A_in = _A_setup()

    def _B_setup():
        B, S, D, F = 1, 2048, 512, 1376
        return {
            "x": _w((lambda *s: torch.randn(*s, dtype=torch.bfloat16) * 0.05)(B, S, D)),
            "w_gate": _w((lambda *s: torch.randn(*s, dtype=torch.bfloat16) * 0.05)(D, F)),
            "w_up": _w((lambda *s: torch.randn(*s, dtype=torch.bfloat16) * 0.05)(D, F)),
            "w_down": _w((lambda *s: torch.randn(*s, dtype=torch.bfloat16) * 0.05)(F, D)),
        }
    _B_in = _B_setup()

    return {
        "A_u": _A_in["u"],
        "A_log_A_real": _A_in["log_A_real"],
        "A_A_imag": _A_in["A_imag"],
        "A_C_real": _A_in["C_real"],
        "A_C_imag": _A_in["C_imag"],
        "A_log_dt": _A_in["log_dt"],
        "A_D_skip": _A_in["D_skip"],
        "B_x": _B_in["x"],
        "B_w_gate": _B_in["w_gate"],
        "B_w_up": _B_in["w_up"],
        "B_w_down": _B_in["w_down"],
        "gate_w": _w((lambda *s: torch.randn(*s, dtype=torch.bfloat16) * 0.05)(512) * 16.0),
    }

def reference(A_u, A_log_A_real, A_A_imag, A_C_real, A_C_imag, A_log_dt, A_D_skip, B_x, B_w_gate, B_w_up, B_w_down, gate_w):
    def _A_ref(u, log_A_real, A_imag, C_real, C_imag, log_dt, D_skip):
        L = u.shape[1]
        dt = torch.exp(log_dt)
        A = -torch.exp(log_A_real) + 1j * A_imag
        C = (C_real + 1j * C_imag) * dt[:, None]
        pos = (lambda x, dt: x.to(dt))(torch.arange(L), log_dt.dtype)
        P = torch.exp((A * dt[:, None])[:, :, None] * pos[None, None, :])
        K = 2.0 * torch.einsum("dn,dnl->dl", C, P).real
        L2 = 2 * L
        u_t = (lambda x, *d: x.permute(*d))(u, 0, 2, 1)
        Kf = (lambda x, *a, **k: torch.fft.rfft(x.float(), *a, **k))(K, L2)
        Uf = (lambda x, *a, **k: torch.fft.rfft(x.float(), *a, **k))(u_t, L2)
        y = (lambda x, *a, **k: torch.fft.irfft(x, *a, **k).to(torch.bfloat16))(Uf * Kf[None, :, :], L2)[:, :, :L]
        y = (lambda x, *d: x.permute(*d))(y, 0, 2, 1)
        return y + u * D_skip[None, None, :]

    def _B_ref(x, w_gate, w_up, w_down):
        return (_gelu(x @ w_gate) * (x @ w_up)) @ w_down

    x = A_u
    g = _sigmoid((x * gate_w).sum(-1, keepdims=True))
    a = _A_ref(x, A_log_A_real, A_A_imag, A_C_real, A_C_imag, A_log_dt, A_D_skip)
    b = _B_ref(x, B_w_gate, B_w_up, B_w_down)
    return g * a + (1 - g) * b
```

```asm
; @launch kernel=gated_mix__ssm_conv_s4d__geglu_ffn__prompt_kernel grid=(512,1,1) block=(256,1,1) lds=81920
; @launch kernel=gm_stage2_kernel grid=(256,1,1) block=(256,1,1) lds=65536
.amdgcn_target "amdgcn-amd-amdhsa--gfx950"
.text
.globl gated_mix__ssm_conv_s4d__geglu_ffn__prompt_kernel
.p2align 8
.type gated_mix__ssm_conv_s4d__geglu_ffn__prompt_kernel,@function
gated_mix__ssm_conv_s4d__geglu_ffn__prompt_kernel:
    s_cmp_ge_u32 s2, 512
    s_cbranch_scc1 L_k1_exit
    s_load_dwordx16 s[16:31], s[0:1], 0
    s_load_dwordx8 s[32:39], s[0:1], 64
    s_load_dwordx4 s[40:43], s[0:1], 96
    s_load_dwordx2 s[44:45], s[0:1], 112
    s_mov_b32 s74, 0x7fff
    s_cmp_ge_u32 s2, 496
    s_cbranch_scc1 L_gate
    s_cmp_ge_u32 s2, 256
    s_cbranch_scc1 L_gemm1
    s_setprio 3
    s_and_b32 s3, s2, 7
    s_lshl_b32 s3, s3, 5
    s_lshr_b32 s4, s2, 3
    s_add_u32 s3, s3, s4
    s_lshl_b32 s4, s3, 2
    s_lshl_b32 s8, s3, 9
    s_lshl_b32 s3, s3, 1
    v_and_b32 v1, 63, v0
    v_lshrrev_b32 v2, 6, v0
    s_nop 0
    v_readfirstlane_b32 s7, v2
    v_lshlrev_b32 v5, 1, v0
    v_add_u32 v5, s8, v5
    s_waitcnt lgkmcnt(0)
    s_load_dword s5, s[26:27], s4
    s_load_dword s6, s[28:29], s4
    s_mov_b32 s56, s18
    s_and_b32 s57, s19, 0xffff
    s_mov_b32 s58, 131072
    s_mov_b32 s59, 0x00020000
    s_mov_b32 s60, s20
    s_and_b32 s61, s21, 0xffff
    s_mov_b32 s62, 131072
    s_mov_b32 s63, 0x00020000
    s_mov_b32 s64, s22
    s_and_b32 s65, s23, 0xffff
    s_mov_b32 s66, 131072
    s_mov_b32 s67, 0x00020000
    s_mov_b32 s68, s24
    s_and_b32 s69, s25, 0xffff
    s_mov_b32 s70, 131072
    s_mov_b32 s71, 0x00020000
    buffer_load_ushort v20, v5, s[56:59], 0 offen
    buffer_load_ushort v21, v5, s[60:63], 0 offen
    buffer_load_ushort v22, v5, s[64:67], 0 offen
    buffer_load_ushort v23, v5, s[68:71], 0 offen
    s_mov_b32 s48, s16
    s_and_b32 s49, s17, 0xffff
    s_mov_b32 s50, 2097152
    s_mov_b32 s51, 0x00020000
    s_mov_b32 s52, s44
    s_and_b32 s53, s45, 0xffff
    s_mov_b32 s54, 268435456
    s_mov_b32 s55, 0x00020000
    v_lshlrev_b32 v81, 13, v0
    v_add_u32 v81, s4, v81
    v_add_u32 v82, 0x1000, v81
    v_mov_b32 v28, 0
    v_mov_b32 v29, 0
    v_mov_b32 v30, 0
    v_mov_b32 v31, 0
    v_lshlrev_b32 v6, 4, v0
    v_bfe_u32 v7, v0, 2, 3
    v_mul_u32_u24 v7, 2240, v7
    v_and_b32 v8, 3, v0
    v_lshl_add_u32 v7, v8, 4, v7
    v_bfe_u32 v8, v0, 1, 3
    v_mul_u32_u24 v8, 2080, v8
    v_and_b32 v9, 1, v0
    v_lshl_add_u32 v8, v9, 4, v8
    v_cmp_gt_u32 vcc, 170, v0
    s_nop 1
    s_and_saveexec_b64 s[72:73], vcc
    s_nop 1
    s_cbranch_execz L_ssm_nz
    ds_write_b128 v6, v[28:31] offset:21504
    ds_write_b128 v6, v[28:31] offset:29344
    ds_write_b128 v7, v[28:31] offset:39360
    ds_write_b128 v8, v[28:31] offset:55104
L_ssm_nz:
    s_mov_b64 exec, s[72:73]
    s_waitcnt lgkmcnt(0)
    s_lshl_b32 s11, s5, 16
    s_and_b32 s12, s5, 0xffff0000
    s_lshl_b32 s13, s6, 16
    s_and_b32 s14, s6, 0xffff0000
    s_cmp_ge_u32 s7, 2
    s_cselect_b32 s11, s12, s11
    s_cselect_b32 s13, s14, s13
    s_lshr_b32 s15, s7, 1
    s_and_b32 s16, s7, 1
    v_mov_b32 v24, s11
    v_mul_f32 v26, 0x3fb8aa3b, v24
    s_mov_b32 s10, 0x3fb8aa3b
    v_fma_f32 v27, v24, s10, -v26
    v_fmac_f32 v27, 0x32a57060, v24
    v_exp_f32 v25, v26
    v_mul_f32 v27, 0x3f317218, v27
    v_fmac_f32 v25, v25, v27
    v_cvt_pk_bf16_f32 v25, v25, v25
    v_lshlrev_b32 v25, 16, v25
    s_waitcnt vmcnt(0)
    v_lshlrev_b32 v20, 16, v20
    v_lshlrev_b32 v21, 16, v21
    v_lshlrev_b32 v22, 16, v22
    v_lshlrev_b32 v23, 16, v23
    v_mul_f32 v26, 0x3fb8aa3b, v20
    s_mov_b32 s10, 0x3fb8aa3b
    v_fma_f32 v27, v20, s10, -v26
    v_fmac_f32 v27, 0x32a57060, v20
    v_exp_f32 v32, v26
    v_mul_f32 v27, 0x3f317218, v27
    v_fmac_f32 v32, v32, v27
    v_cvt_pk_bf16_f32 v32, v32, v32
    v_lshlrev_b32 v32, 16, v32
    v_mul_f32 v32, v32, v25
    v_mul_f32 v32, 0xbfb8aa3b, v32
    v_mul_f32 v33, v21, v25
    v_mul_f32 v33, 0x3e22f983, v33
    v_mul_f32 v34, v22, v25
    v_mul_f32 v35, v23, v25
    v_add_f32 v34, v34, v34
    v_add_f32 v35, v35, v35
    ds_write_b128 v6, v[32:35] offset:0
    v_and_b32 v2, 31, v1
    v_lshrrev_b32 v3, 5, v1
    v_mov_b32 v4, 0
    s_mov_b32 s17, 0x3f800000
    v_writelane_b32 v4, s17, 1
    v_writelane_b32 v4, s17, 33
    s_mov_b32 s17, 0x40000000
    v_writelane_b32 v4, s17, 2
    v_writelane_b32 v4, s17, 34
    s_mov_b32 s17, 0x40400000
    v_writelane_b32 v4, s17, 3
    v_writelane_b32 v4, s17, 35
    s_mov_b32 s17, 0x40800000
    v_writelane_b32 v4, s17, 4
    v_writelane_b32 v4, s17, 36
    s_mov_b32 s17, 0x40a00000
    v_writelane_b32 v4, s17, 5
    v_writelane_b32 v4, s17, 37
    s_mov_b32 s17, 0x40c00000
    v_writelane_b32 v4, s17, 6
    v_writelane_b32 v4, s17, 38
    s_mov_b32 s17, 0x40e00000
    v_writelane_b32 v4, s17, 7
    v_writelane_b32 v4, s17, 39
    s_mov_b32 s17, 0x43800000
    v_writelane_b32 v4, s17, 8
    v_writelane_b32 v4, s17, 40
    s_mov_b32 s17, 0x43810000
    v_writelane_b32 v4, s17, 9
    v_writelane_b32 v4, s17, 41
    s_mov_b32 s17, 0x43820000
    v_writelane_b32 v4, s17, 10
    v_writelane_b32 v4, s17, 42
    s_mov_b32 s17, 0x43830000
    v_writelane_b32 v4, s17, 11
    v_writelane_b32 v4, s17, 43
    s_mov_b32 s17, 0x44000000
    v_writelane_b32 v4, s17, 12
    v_writelane_b32 v4, s17, 44
    s_mov_b32 s17, 0x44010000
    v_writelane_b32 v4, s17, 13
    v_writelane_b32 v4, s17, 45
    s_mov_b32 s17, 0x44400000
    v_writelane_b32 v4, s17, 14
    v_writelane_b32 v4, s17, 46
    s_mov_b32 s17, 0x44410000
    v_writelane_b32 v4, s17, 15
    v_writelane_b32 v4, s17, 47
    s_mov_b32 s17, 0x44800000
    v_writelane_b32 v4, s17, 16
    v_writelane_b32 v4, s17, 48
    s_mov_b32 s17, 0x44a00000
    v_writelane_b32 v4, s17, 17
    v_writelane_b32 v4, s17, 49
    s_mov_b32 s17, 0x44c00000
    v_writelane_b32 v4, s17, 18
    v_writelane_b32 v4, s17, 50
    s_mov_b32 s17, 0x44e00000
    v_writelane_b32 v4, s17, 19
    v_writelane_b32 v4, s17, 51
    s_mov_b32 s17, 0x45000000
    v_writelane_b32 v4, s17, 20
    v_writelane_b32 v4, s17, 52
    s_mov_b32 s17, 0x44000000
    v_writelane_b32 v4, s17, 21
    v_writelane_b32 v4, s17, 53
    s_mov_b32 s17, 0x44800000
    v_writelane_b32 v4, s17, 22
    v_writelane_b32 v4, s17, 54
    v_lshlrev_b32 v5, 3, v2
    v_cvt_f32_u32 v5, v5
    s_lshl_b32 s17, s7, 10
    v_lshlrev_b32 v7, 6, v3
    v_add_u32 v7, s17, v7
    v_mov_b32 v40, 0
    v_mov_b32 v41, 0
    v_mov_b32 v42, 0
    v_mov_b32 v43, 0
    v_mov_b32 v44, 0
    v_mov_b32 v45, 0
    v_mov_b32 v46, 0
    v_mov_b32 v47, 0
    v_mov_b32 v48, 0
    v_mov_b32 v49, 0
    v_mov_b32 v50, 0
    v_mov_b32 v51, 0
    v_mov_b32 v52, 0
    v_mov_b32 v53, 0
    v_mov_b32 v54, 0
    v_mov_b32 v55, 0
    s_waitcnt lgkmcnt(0)
    s_barrier
    v_mov_b32 v56, v4
    v_mov_b32 v57, v4
    v_mov_b32 v58, v5
    v_mov_b32 v59, v5
    ds_read_b128 v[8:11], v7 offset:0
    ds_read_b128 v[12:15], v7 offset:16
    s_waitcnt lgkmcnt(1)
    v_mul_f32 v20, v8, v4
    v_mul_f32 v21, v9, v4
    v_mul_f32 v22, v8, v5
    v_mul_f32 v23, v9, v5
    v_exp_f32 v20, v20
    v_cos_f32 v24, v21
    v_sin_f32 v25, v21
    v_exp_f32 v22, v22
    v_cos_f32 v26, v23
    v_sin_f32 v27, v23
    ds_read_b128 v[16:19], v7 offset:32
    s_waitcnt lgkmcnt(1)
    v_mul_f32 v32, v24, v20
    v_mul_f32 v33, v25, v20
    v_mul_f32 v60, v12, v4
    v_mul_f32 v34, v26, v22
    v_mul_f32 v35, -v27, v22
    v_mul_f32 v61, v13, v4
    v_mul_f32 v36, v32, v10
    v_mul_f32 v37, v33, v10
    v_mul_f32 v62, v12, v5
    v_cvt_pk_bf16_f32 v96, v34, v35
    v_fma_f32 v36, -v33, v11, v36
    v_mul_f32 v63, v13, v5
    v_fma_f32 v37, v32, v11, v37
    v_lshlrev_b32 v38, 16, v96
    v_exp_f32 v60, v60
    v_and_b32 v39, 0xffff0000, v96
    v_cvt_pk_bf16_f32 v88, v36, v37
    v_cos_f32 v64, v61
    v_sub_f32 v34, v34, v38
    v_sub_f32 v35, v35, v39
    v_sin_f32 v65, v61
    v_lshlrev_b32 v32, 16, v88
    v_and_b32 v33, 0xffff0000, v88
    v_exp_f32 v62, v62
    v_cvt_pk_bf16_f32 v100, v34, v35
    v_sub_f32 v36, v36, v32
    v_cos_f32 v66, v63
    v_sub_f32 v37, v37, v33
    v_cvt_pk_bf16_f32 v92, v36, v37
    v_sin_f32 v67, v63
    ds_read_b128 v[8:11], v7 offset:48
    s_waitcnt lgkmcnt(1)
    v_mul_f32 v32, v64, v60
    v_mul_f32 v33, v65, v60
    v_mul_f32 v20, v16, v4
    v_mul_f32 v34, v66, v62
    v_mul_f32 v35, -v67, v62
    v_mul_f32 v21, v17, v4
    v_mul_f32 v36, v32, v14
    v_mul_f32 v37, v33, v14
    v_mul_f32 v22, v16, v5
    v_cvt_pk_bf16_f32 v97, v34, v35
    v_fma_f32 v36, -v33, v15, v36
    v_mul_f32 v23, v17, v5
    v_fma_f32 v37, v32, v15, v37
    v_lshlrev_b32 v38, 16, v97
    v_exp_f32 v20, v20
    v_and_b32 v39, 0xffff0000, v97
    v_cvt_pk_bf16_f32 v89, v36, v37
    v_cos_f32 v24, v21
    v_sub_f32 v34, v34, v38
    v_sub_f32 v35, v35, v39
    v_sin_f32 v25, v21
    v_lshlrev_b32 v32, 16, v89
    v_and_b32 v33, 0xffff0000, v89
    v_exp_f32 v22, v22
    v_cvt_pk_bf16_f32 v101, v34, v35
    v_sub_f32 v36, v36, v32
    v_cos_f32 v26, v23
    v_sub_f32 v37, v37, v33
    v_cvt_pk_bf16_f32 v93, v36, v37
    v_sin_f32 v27, v23
    ds_read_b128 v[12:15], v7 offset:128
    s_waitcnt lgkmcnt(1)
    v_mul_f32 v32, v24, v20
    v_mul_f32 v33, v25, v20
    v_mul_f32 v60, v8, v4
    v_mul_f32 v34, v26, v22
    v_mul_f32 v35, -v27, v22
    v_mul_f32 v61, v9, v4
    v_mul_f32 v36, v32, v18
    v_mul_f32 v37, v33, v18
    v_mul_f32 v62, v8, v5
    v_cvt_pk_bf16_f32 v98, v34, v35
    v_fma_f32 v36, -v33, v19, v36
    v_mul_f32 v63, v9, v5
    v_fma_f32 v37, v32, v19, v37
    v_lshlrev_b32 v38, 16, v98
    v_exp_f32 v60, v60
    v_and_b32 v39, 0xffff0000, v98
    v_cvt_pk_bf16_f32 v90, v36, v37
    v_cos_f32 v64, v61
    v_sub_f32 v34, v34, v38
    v_sub_f32 v35, v35, v39
    v_sin_f32 v65, v61
    v_lshlrev_b32 v32, 16, v90
    v_and_b32 v33, 0xffff0000, v90
    v_exp_f32 v62, v62
    v_cvt_pk_bf16_f32 v102, v34, v35
    v_sub_f32 v36, v36, v32
    v_cos_f32 v66, v63
    v_sub_f32 v37, v37, v33
    v_cvt_pk_bf16_f32 v94, v36, v37
    v_sin_f32 v67, v63
    ds_read_b128 v[16:19], v7 offset:144
    s_waitcnt lgkmcnt(1)
    v_mul_f32 v32, v64, v60
    v_mul_f32 v33, v65, v60
    v_mul_f32 v20, v12, v4
    v_mul_f32 v34, v66, v62
    v_mul_f32 v35, -v67, v62
    v_mul_f32 v21, v13, v4
    v_mul_f32 v36, v32, v10
    v_mul_f32 v37, v33, v10
    v_mul_f32 v22, v12, v5
    v_cvt_pk_bf16_f32 v99, v34, v35
    v_fma_f32 v36, -v33, v11, v36
    v_mul_f32 v23, v13, v5
    v_fma_f32 v37, v32, v11, v37
    v_lshlrev_b32 v38, 16, v99
    v_exp_f32 v20, v20
    v_and_b32 v39, 0xffff0000, v99
    v_cvt_pk_bf16_f32 v91, v36, v37
    v_cos_f32 v24, v21
    v_sub_f32 v34, v34, v38
    v_sub_f32 v35, v35, v39
    v_sin_f32 v25, v21
    v_lshlrev_b32 v32, 16, v91
    v_and_b32 v33, 0xffff0000, v91
    v_exp_f32 v22, v22
    v_cvt_pk_bf16_f32 v103, v34, v35
    v_sub_f32 v36, v36, v32
    v_cos_f32 v26, v23
    v_sub_f32 v37, v37, v33
    v_cvt_pk_bf16_f32 v95, v36, v37
    v_sin_f32 v27, v23
    v_mfma_f32_32x32x16_bf16 v[40:55], v[88:91], v[96:99], v[40:55]
    v_mfma_f32_32x32x16_bf16 v[40:55], v[88:91], v[100:103], v[40:55]
    v_mfma_f32_32x32x16_bf16 v[40:55], v[92:95], v[96:99], v[40:55]
    ds_read_b128 v[8:11], v7 offset:160
    s_waitcnt lgkmcnt(1)
    v_mul_f32 v32, v24, v20
    v_mul_f32 v33, v25, v20
    v_mul_f32 v60, v16, v4
    v_mul_f32 v34, v26, v22
    v_mul_f32 v35, -v27, v22
    v_mul_f32 v61, v17, v4
    v_mul_f32 v36, v32, v14
    v_mul_f32 v37, v33, v14
    v_mul_f32 v62, v16, v5
    v_cvt_pk_bf16_f32 v112, v34, v35
    v_fma_f32 v36, -v33, v15, v36
    v_mul_f32 v63, v17, v5
    v_fma_f32 v37, v32, v15, v37
    v_lshlrev_b32 v38, 16, v112
    v_exp_f32 v60, v60
    v_and_b32 v39, 0xffff0000, v112
    v_cvt_pk_bf16_f32 v104, v36, v37
    v_cos_f32 v64, v61
    v_sub_f32 v34, v34, v38
    v_sub_f32 v35, v35, v39
    v_sin_f32 v65, v61
    v_lshlrev_b32 v32, 16, v104
    v_and_b32 v33, 0xffff0000, v104
    v_exp_f32 v62, v62
    v_cvt_pk_bf16_f32 v116, v34, v35
    v_sub_f32 v36, v36, v32
    v_cos_f32 v66, v63
    v_sub_f32 v37, v37, v33
    v_cvt_pk_bf16_f32 v108, v36, v37
    v_sin_f32 v67, v63
    ds_read_b128 v[12:15], v7 offset:176
    s_waitcnt lgkmcnt(1)
    v_mul_f32 v32, v64, v60
    v_mul_f32 v33, v65, v60
    v_mul_f32 v20, v8, v4
    v_mul_f32 v34, v66, v62
    v_mul_f32 v35, -v67, v62
    v_mul_f32 v21, v9, v4
    v_mul_f32 v36, v32, v18
    v_mul_f32 v37, v33, v18
    v_mul_f32 v22, v8, v5
    v_cvt_pk_bf16_f32 v113, v34, v35
    v_fma_f32 v36, -v33, v19, v36
    v_mul_f32 v23, v9, v5
    v_fma_f32 v37, v32, v19, v37
    v_lshlrev_b32 v38, 16, v113
    v_exp_f32 v20, v20
    v_and_b32 v39, 0xffff0000, v113
    v_cvt_pk_bf16_f32 v105, v36, v37
    v_cos_f32 v24, v21
    v_sub_f32 v34, v34, v38
    v_sub_f32 v35, v35, v39
    v_sin_f32 v25, v21
    v_lshlrev_b32 v32, 16, v105
    v_and_b32 v33, 0xffff0000, v105
    v_exp_f32 v22, v22
    v_cvt_pk_bf16_f32 v117, v34, v35
    v_sub_f32 v36, v36, v32
    v_cos_f32 v26, v23
    v_sub_f32 v37, v37, v33
    v_cvt_pk_bf16_f32 v109, v36, v37
    v_sin_f32 v27, v23
    ds_read_b128 v[16:19], v7 offset:256
    s_waitcnt lgkmcnt(1)
    v_mul_f32 v32, v24, v20
    v_mul_f32 v33, v25, v20
    v_mul_f32 v60, v12, v4
    v_mul_f32 v34, v26, v22
    v_mul_f32 v35, -v27, v22
    v_mul_f32 v61, v13, v4
    v_mul_f32 v36, v32, v10
    v_mul_f32 v37, v33, v10
    v_mul_f32 v62, v12, v5
    v_cvt_pk_bf16_f32 v114, v34, v35
    v_fma_f32 v36, -v33, v11, v36
    v_mul_f32 v63, v13, v5
    v_fma_f32 v37, v32, v11, v37
    v_lshlrev_b32 v38, 16, v114
    v_exp_f32 v60, v60
    v_and_b32 v39, 0xffff0000, v114
    v_cvt_pk_bf16_f32 v106, v36, v37
    v_cos_f32 v64, v61
    v_sub_f32 v34, v34, v38
    v_sub_f32 v35, v35, v39
    v_sin_f32 v65, v61
    v_lshlrev_b32 v32, 16, v106
    v_and_b32 v33, 0xffff0000, v106
    v_exp_f32 v62, v62
    v_cvt_pk_bf16_f32 v118, v34, v35
    v_sub_f32 v36, v36, v32
    v_cos_f32 v66, v63
    v_sub_f32 v37, v37, v33
    v_cvt_pk_bf16_f32 v110, v36, v37
    v_sin_f32 v67, v63
    ds_read_b128 v[8:11], v7 offset:272
    s_waitcnt lgkmcnt(1)
    v_mul_f32 v32, v64, v60
    v_mul_f32 v33, v65, v60
    v_mul_f32 v20, v16, v4
    v_mul_f32 v34, v66, v62
    v_mul_f32 v35, -v67, v62
    v_mul_f32 v21, v17, v4
    v_mul_f32 v36, v32, v14
    v_mul_f32 v37, v33, v14
    v_mul_f32 v22, v16, v5
    v_cvt_pk_bf16_f32 v115, v34, v35
    v_fma_f32 v36, -v33, v15, v36
    v_mul_f32 v23, v17, v5
    v_fma_f32 v37, v32, v15, v37
    v_lshlrev_b32 v38, 16, v115
    v_exp_f32 v20, v20
    v_and_b32 v39, 0xffff0000, v115
    v_cvt_pk_bf16_f32 v107, v36, v37
    v_cos_f32 v24, v21
    v_sub_f32 v34, v34, v38
    v_sub_f32 v35, v35, v39
    v_sin_f32 v25, v21
    v_lshlrev_b32 v32, 16, v107
    v_and_b32 v33, 0xffff0000, v107
    v_exp_f32 v22, v22
    v_cvt_pk_bf16_f32 v119, v34, v35
    v_sub_f32 v36, v36, v32
    v_cos_f32 v26, v23
    v_sub_f32 v37, v37, v33
    v_cvt_pk_bf16_f32 v111, v36, v37
    v_sin_f32 v27, v23
    v_mfma_f32_32x32x16_bf16 v[40:55], v[104:107], v[112:115], v[40:55]
    v_mfma_f32_32x32x16_bf16 v[40:55], v[104:107], v[116:119], v[40:55]
    v_mfma_f32_32x32x16_bf16 v[40:55], v[108:111], v[112:115], v[40:55]
    ds_read_b128 v[12:15], v7 offset:288
    s_waitcnt lgkmcnt(1)
    v_mul_f32 v32, v24, v20
    v_mul_f32 v33, v25, v20
    v_mul_f32 v60, v8, v4
    v_mul_f32 v34, v26, v22
    v_mul_f32 v35, -v27, v22
    v_mul_f32 v61, v9, v4
    v_mul_f32 v36, v32, v18
    v_mul_f32 v37, v33, v18
    v_mul_f32 v62, v8, v5
    v_cvt_pk_bf16_f32 v96, v34, v35
    v_fma_f32 v36, -v33, v19, v36
    v_mul_f32 v63, v9, v5
    v_fma_f32 v37, v32, v19, v37
    v_lshlrev_b32 v38, 16, v96
    v_exp_f32 v60, v60
    v_and_b32 v39, 0xffff0000, v96
    v_cvt_pk_bf16_f32 v88, v36, v37
    v_cos_f32 v64, v61
    v_sub_f32 v34, v34, v38
    v_sub_f32 v35, v35, v39
    v_sin_f32 v65, v61
    v_lshlrev_b32 v32, 16, v88
    v_and_b32 v33, 0xffff0000, v88
    v_exp_f32 v62, v62
    v_cvt_pk_bf16_f32 v100, v34, v35
    v_sub_f32 v36, v36, v32
    v_cos_f32 v66, v63
    v_sub_f32 v37, v37, v33
    v_cvt_pk_bf16_f32 v92, v36, v37
    v_sin_f32 v67, v63
    ds_read_b128 v[16:19], v7 offset:304
    s_waitcnt lgkmcnt(1)
    v_mul_f32 v32, v64, v60
    v_mul_f32 v33, v65, v60
    v_mul_f32 v20, v12, v4
    v_mul_f32 v34, v66, v62
    v_mul_f32 v35, -v67, v62
    v_mul_f32 v21, v13, v4
    v_mul_f32 v36, v32, v10
    v_mul_f32 v37, v33, v10
    v_mul_f32 v22, v12, v5
    v_cvt_pk_bf16_f32 v97, v34, v35
    v_fma_f32 v36, -v33, v11, v36
    v_mul_f32 v23, v13, v5
    v_fma_f32 v37, v32, v11, v37
    v_lshlrev_b32 v38, 16, v97
    v_exp_f32 v20, v20
    v_and_b32 v39, 0xffff0000, v97
    v_cvt_pk_bf16_f32 v89, v36, v37
    v_cos_f32 v24, v21
    v_sub_f32 v34, v34, v38
    v_sub_f32 v35, v35, v39
    v_sin_f32 v25, v21
    v_lshlrev_b32 v32, 16, v89
    v_and_b32 v33, 0xffff0000, v89
    v_exp_f32 v22, v22
    v_cvt_pk_bf16_f32 v101, v34, v35
    v_sub_f32 v36, v36, v32
    v_cos_f32 v26, v23
    v_sub_f32 v37, v37, v33
    v_cvt_pk_bf16_f32 v93, v36, v37
    v_sin_f32 v27, v23
    ds_read_b128 v[8:11], v7 offset:384
    s_waitcnt lgkmcnt(1)
    v_mul_f32 v32, v24, v20
    v_mul_f32 v33, v25, v20
    v_mul_f32 v60, v16, v4
    v_mul_f32 v34, v26, v22
    v_mul_f32 v35, -v27, v22
    v_mul_f32 v61, v17, v4
    v_mul_f32 v36, v32, v14
    v_mul_f32 v37, v33, v14
    v_mul_f32 v62, v16, v5
    v_cvt_pk_bf16_f32 v98, v34, v35
    v_fma_f32 v36, -v33, v15, v36
    v_mul_f32 v63, v17, v5
    v_fma_f32 v37, v32, v15, v37
    v_lshlrev_b32 v38, 16, v98
    v_exp_f32 v60, v60
    v_and_b32 v39, 0xffff0000, v98
    v_cvt_pk_bf16_f32 v90, v36, v37
    v_cos_f32 v64, v61
    v_sub_f32 v34, v34, v38
    v_sub_f32 v35, v35, v39
    v_sin_f32 v65, v61
    v_lshlrev_b32 v32, 16, v90
    v_and_b32 v33, 0xffff0000, v90
    v_exp_f32 v62, v62
    v_cvt_pk_bf16_f32 v102, v34, v35
    v_sub_f32 v36, v36, v32
    v_cos_f32 v66, v63
    v_sub_f32 v37, v37, v33
    v_cvt_pk_bf16_f32 v94, v36, v37
    v_sin_f32 v67, v63
    ds_read_b128 v[12:15], v7 offset:400
    s_waitcnt lgkmcnt(1)
    v_mul_f32 v32, v64, v60
    v_mul_f32 v33, v65, v60
    v_mul_f32 v20, v8, v4
    v_mul_f32 v34, v66, v62
    v_mul_f32 v35, -v67, v62
    v_mul_f32 v21, v9, v4
    v_mul_f32 v36, v32, v18
    v_mul_f32 v37, v33, v18
    v_mul_f32 v22, v8, v5
    v_cvt_pk_bf16_f32 v99, v34, v35
    v_fma_f32 v36, -v33, v19, v36
    v_mul_f32 v23, v9, v5
    v_fma_f32 v37, v32, v19, v37
    v_lshlrev_b32 v38, 16, v99
    v_exp_f32 v20, v20
    v_and_b32 v39, 0xffff0000, v99
    v_cvt_pk_bf16_f32 v91, v36, v37
    v_cos_f32 v24, v21
    v_sub_f32 v34, v34, v38
    v_sub_f32 v35, v35, v39
    v_sin_f32 v25, v21
    v_lshlrev_b32 v32, 16, v91
    v_and_b32 v33, 0xffff0000, v91
    v_exp_f32 v22, v22
    v_cvt_pk_bf16_f32 v103, v34, v35
    v_sub_f32 v36, v36, v32
    v_cos_f32 v26, v23
    v_sub_f32 v37, v37, v33
    v_cvt_pk_bf16_f32 v95, v36, v37
    v_sin_f32 v27, v23
    v_mfma_f32_32x32x16_bf16 v[40:55], v[88:91], v[96:99], v[40:55]
    v_mfma_f32_32x32x16_bf16 v[40:55], v[88:91], v[100:103], v[40:55]
    v_mfma_f32_32x32x16_bf16 v[40:55], v[92:95], v[96:99], v[40:55]
    ds_read_b128 v[16:19], v7 offset:416
    s_waitcnt lgkmcnt(1)
    v_mul_f32 v32, v24, v20
    v_mul_f32 v33, v25, v20
    v_mul_f32 v60, v12, v4
    v_mul_f32 v34, v26, v22
    v_mul_f32 v35, -v27, v22
    v_mul_f32 v61, v13, v4
    v_mul_f32 v36, v32, v10
    v_mul_f32 v37, v33, v10
    v_mul_f32 v62, v12, v5
    v_cvt_pk_bf16_f32 v112, v34, v35
    v_fma_f32 v36, -v33, v11, v36
    v_mul_f32 v63, v13, v5
    v_fma_f32 v37, v32, v11, v37
    v_lshlrev_b32 v38, 16, v112
    v_exp_f32 v60, v60
    v_and_b32 v39, 0xffff0000, v112
    v_cvt_pk_bf16_f32 v104, v36, v37
    v_cos_f32 v64, v61
    v_sub_f32 v34, v34, v38
    v_sub_f32 v35, v35, v39
    v_sin_f32 v65, v61
    v_lshlrev_b32 v32, 16, v104
    v_and_b32 v33, 0xffff0000, v104
    v_exp_f32 v62, v62
    v_cvt_pk_bf16_f32 v116, v34, v35
    v_sub_f32 v36, v36, v32
    v_cos_f32 v66, v63
    v_sub_f32 v37, v37, v33
    v_cvt_pk_bf16_f32 v108, v36, v37
    v_sin_f32 v67, v63
    ds_read_b128 v[8:11], v7 offset:432
    s_waitcnt lgkmcnt(1)
    v_mul_f32 v32, v64, v60
    v_mul_f32 v33, v65, v60
    v_mul_f32 v20, v16, v4
    v_mul_f32 v34, v66, v62
    v_mul_f32 v35, -v67, v62
    v_mul_f32 v21, v17, v4
    v_mul_f32 v36, v32, v14
    v_mul_f32 v37, v33, v14
    v_mul_f32 v22, v16, v5
    v_cvt_pk_bf16_f32 v113, v34, v35
    v_fma_f32 v36, -v33, v15, v36
    v_mul_f32 v23, v17, v5
    v_fma_f32 v37, v32, v15, v37
    v_lshlrev_b32 v38, 16, v113
    v_exp_f32 v20, v20
    v_and_b32 v39, 0xffff0000, v113
    v_cvt_pk_bf16_f32 v105, v36, v37
    v_cos_f32 v24, v21
    v_sub_f32 v34, v34, v38
    v_sub_f32 v35, v35, v39
    v_sin_f32 v25, v21
    v_lshlrev_b32 v32, 16, v105
    v_and_b32 v33, 0xffff0000, v105
    v_exp_f32 v22, v22
    v_cvt_pk_bf16_f32 v117, v34, v35
    v_sub_f32 v36, v36, v32
    v_cos_f32 v26, v23
    v_sub_f32 v37, v37, v33
    v_cvt_pk_bf16_f32 v109, v36, v37
    v_sin_f32 v27, v23
    ds_read_b128 v[12:15], v7 offset:512
    s_waitcnt lgkmcnt(1)
    buffer_load_dword v72, v81, s[48:51], 0 offen offset:0
    v_mul_f32 v32, v24, v20
    v_mul_f32 v33, v25, v20
    v_mul_f32 v60, v8, v4
    v_mul_f32 v34, v26, v22
    v_mul_f32 v35, -v27, v22
    v_mul_f32 v61, v9, v4
    v_mul_f32 v36, v32, v18
    v_mul_f32 v37, v33, v18
    v_mul_f32 v62, v8, v5
    v_cvt_pk_bf16_f32 v114, v34, v35
    v_fma_f32 v36, -v33, v19, v36
    v_mul_f32 v63, v9, v5
    v_fma_f32 v37, v32, v19, v37
    v_lshlrev_b32 v38, 16, v114
    v_exp_f32 v60, v60
    v_and_b32 v39, 0xffff0000, v114
    v_cvt_pk_bf16_f32 v106, v36, v37
    v_cos_f32 v64, v61
    v_sub_f32 v34, v34, v38
    v_sub_f32 v35, v35, v39
    v_sin_f32 v65, v61
    v_lshlrev_b32 v32, 16, v106
    v_and_b32 v33, 0xffff0000, v106
    v_exp_f32 v62, v62
    v_cvt_pk_bf16_f32 v118, v34, v35
    v_sub_f32 v36, v36, v32
    v_cos_f32 v66, v63
    v_sub_f32 v37, v37, v33
    v_cvt_pk_bf16_f32 v110, v36, v37
    v_sin_f32 v67, v63
    ds_read_b128 v[16:19], v7 offset:528
    s_waitcnt lgkmcnt(1)
    v_mul_f32 v32, v64, v60
    v_mul_f32 v33, v65, v60
    v_mul_f32 v20, v12, v4
    v_mul_f32 v34, v66, v62
    v_mul_f32 v35, -v67, v62
    v_mul_f32 v21, v13, v4
    v_mul_f32 v36, v32, v10
    v_mul_f32 v37, v33, v10
    v_mul_f32 v22, v12, v5
    v_cvt_pk_bf16_f32 v115, v34, v35
    v_fma_f32 v36, -v33, v11, v36
    v_mul_f32 v23, v13, v5
    v_fma_f32 v37, v32, v11, v37
    v_lshlrev_b32 v38, 16, v115
    v_exp_f32 v20, v20
    v_and_b32 v39, 0xffff0000, v115
    v_cvt_pk_bf16_f32 v107, v36, v37
    v_cos_f32 v24, v21
    v_sub_f32 v34, v34, v38
    v_sub_f32 v35, v35, v39
    v_sin_f32 v25, v21
    v_lshlrev_b32 v32, 16, v107
    v_and_b32 v33, 0xffff0000, v107
    v_exp_f32 v22, v22
    v_cvt_pk_bf16_f32 v119, v34, v35
    v_sub_f32 v36, v36, v32
    v_cos_f32 v26, v23
    v_sub_f32 v37, v37, v33
    v_cvt_pk_bf16_f32 v111, v36, v37
    v_sin_f32 v27, v23
    v_mfma_f32_32x32x16_bf16 v[40:55], v[104:107], v[112:115], v[40:55]
    v_mfma_f32_32x32x16_bf16 v[40:55], v[104:107], v[116:119], v[40:55]
    v_mfma_f32_32x32x16_bf16 v[40:55], v[108:111], v[112:115], v[40:55]
    ds_read_b128 v[8:11], v7 offset:544
    s_waitcnt lgkmcnt(1)
    buffer_load_dword v73, v81, s[48:51], 0 offen offset:1024
    v_mul_f32 v32, v24, v20
    v_mul_f32 v33, v25, v20
    v_mul_f32 v60, v16, v4
    v_mul_f32 v34, v26, v22
    v_mul_f32 v35, -v27, v22
    v_mul_f32 v61, v17, v4
    v_mul_f32 v36, v32, v14
    v_mul_f32 v37, v33, v14
    v_mul_f32 v62, v16, v5
    v_cvt_pk_bf16_f32 v96, v34, v35
    v_fma_f32 v36, -v33, v15, v36
    v_mul_f32 v63, v17, v5
    v_fma_f32 v37, v32, v15, v37
    v_lshlrev_b32 v38, 16, v96
    v_exp_f32 v60, v60
    v_and_b32 v39, 0xffff0000, v96
    v_cvt_pk_bf16_f32 v88, v36, v37
    v_cos_f32 v64, v61
    v_sub_f32 v34, v34, v38
    v_sub_f32 v35, v35, v39
    v_sin_f32 v65, v61
    v_lshlrev_b32 v32, 16, v88
    v_and_b32 v33, 0xffff0000, v88
    v_exp_f32 v62, v62
    v_cvt_pk_bf16_f32 v100, v34, v35
    v_sub_f32 v36, v36, v32
    v_cos_f32 v66, v63
    v_sub_f32 v37, v37, v33
    v_cvt_pk_bf16_f32 v92, v36, v37
    v_sin_f32 v67, v63
    ds_read_b128 v[12:15], v7 offset:560
    s_waitcnt lgkmcnt(1)
    v_mul_f32 v32, v64, v60
    v_mul_f32 v33, v65, v60
    v_mul_f32 v20, v8, v4
    v_mul_f32 v34, v66, v62
    v_mul_f32 v35, -v67, v62
    v_mul_f32 v21, v9, v4
    v_mul_f32 v36, v32, v18
    v_mul_f32 v37, v33, v18
    v_mul_f32 v22, v8, v5
    v_cvt_pk_bf16_f32 v97, v34, v35
    v_fma_f32 v36, -v33, v19, v36
    v_mul_f32 v23, v9, v5
    v_fma_f32 v37, v32, v19, v37
    v_lshlrev_b32 v38, 16, v97
    v_exp_f32 v20, v20
    v_and_b32 v39, 0xffff0000, v97
    v_cvt_pk_bf16_f32 v89, v36, v37
    v_cos_f32 v24, v21
    v_sub_f32 v34, v34, v38
    v_sub_f32 v35, v35, v39
    v_sin_f32 v25, v21
    v_lshlrev_b32 v32, 16, v89
    v_and_b32 v33, 0xffff0000, v89
    v_exp_f32 v22, v22
    v_cvt_pk_bf16_f32 v101, v34, v35
    v_sub_f32 v36, v36, v32
    v_cos_f32 v26, v23
    v_sub_f32 v37, v37, v33
    v_cvt_pk_bf16_f32 v93, v36, v37
    v_sin_f32 v27, v23
    ds_read_b128 v[16:19], v7 offset:640
    s_waitcnt lgkmcnt(1)
    buffer_load_dword v74, v81, s[48:51], 0 offen offset:2048
    v_mul_f32 v32, v24, v20
    v_mul_f32 v33, v25, v20
    v_mul_f32 v60, v12, v4
    v_mul_f32 v34, v26, v22
    v_mul_f32 v35, -v27, v22
    v_mul_f32 v61, v13, v4
    v_mul_f32 v36, v32, v10
    v_mul_f32 v37, v33, v10
    v_mul_f32 v62, v12, v5
    v_cvt_pk_bf16_f32 v98, v34, v35
    v_fma_f32 v36, -v33, v11, v36
    v_mul_f32 v63, v13, v5
    v_fma_f32 v37, v32, v11, v37
    v_lshlrev_b32 v38, 16, v98
    v_exp_f32 v60, v60
    v_and_b32 v39, 0xffff0000, v98
    v_cvt_pk_bf16_f32 v90, v36, v37
    v_cos_f32 v64, v61
    v_sub_f32 v34, v34, v38
    v_sub_f32 v35, v35, v39
    v_sin_f32 v65, v61
    v_lshlrev_b32 v32, 16, v90
    v_and_b32 v33, 0xffff0000, v90
    v_exp_f32 v62, v62
    v_cvt_pk_bf16_f32 v102, v34, v35
    v_sub_f32 v36, v36, v32
    v_cos_f32 v66, v63
    v_sub_f32 v37, v37, v33
    v_cvt_pk_bf16_f32 v94, v36, v37
    v_sin_f32 v67, v63
    ds_read_b128 v[8:11], v7 offset:656
    s_waitcnt lgkmcnt(1)
    v_mul_f32 v32, v64, v60
    v_mul_f32 v33, v65, v60
    v_mul_f32 v20, v16, v4
    v_mul_f32 v34, v66, v62
    v_mul_f32 v35, -v67, v62
    v_mul_f32 v21, v17, v4
    v_mul_f32 v36, v32, v14
    v_mul_f32 v37, v33, v14
    v_mul_f32 v22, v16, v5
    v_cvt_pk_bf16_f32 v99, v34, v35
    v_fma_f32 v36, -v33, v15, v36
    v_mul_f32 v23, v17, v5
    v_fma_f32 v37, v32, v15, v37
    v_lshlrev_b32 v38, 16, v99
    v_exp_f32 v20, v20
    v_and_b32 v39, 0xffff0000, v99
    v_cvt_pk_bf16_f32 v91, v36, v37
    v_cos_f32 v24, v21
    v_sub_f32 v34, v34, v38
    v_sub_f32 v35, v35, v39
    v_sin_f32 v25, v21
    v_lshlrev_b32 v32, 16, v91
    v_and_b32 v33, 0xffff0000, v91
    v_exp_f32 v22, v22
    v_cvt_pk_bf16_f32 v103, v34, v35
    v_sub_f32 v36, v36, v32
    v_cos_f32 v26, v23
    v_sub_f32 v37, v37, v33
    v_cvt_pk_bf16_f32 v95, v36, v37
    v_sin_f32 v27, v23
    v_mfma_f32_32x32x16_bf16 v[40:55], v[88:91], v[96:99], v[40:55]
    v_mfma_f32_32x32x16_bf16 v[40:55], v[88:91], v[100:103], v[40:55]
    v_mfma_f32_32x32x16_bf16 v[40:55], v[92:95], v[96:99], v[40:55]
    ds_read_b128 v[12:15], v7 offset:672
    s_waitcnt lgkmcnt(1)
    v_mul_f32 v32, v24, v20
    v_mul_f32 v33, v25, v20
    v_mul_f32 v60, v8, v4
    v_mul_f32 v34, v26, v22
    v_mul_f32 v35, -v27, v22
    v_mul_f32 v61, v9, v4
    v_mul_f32 v36, v32, v18
    v_mul_f32 v37, v33, v18
    v_mul_f32 v62, v8, v5
    v_cvt_pk_bf16_f32 v112, v34, v35
    v_fma_f32 v36, -v33, v19, v36
    v_mul_f32 v63, v9, v5
    v_fma_f32 v37, v32, v19, v37
    v_lshlrev_b32 v38, 16, v112
    v_exp_f32 v60, v60
    v_and_b32 v39, 0xffff0000, v112
    v_cvt_pk_bf16_f32 v104, v36, v37
    v_cos_f32 v64, v61
    v_sub_f32 v34, v34, v38
    v_sub_f32 v35, v35, v39
    v_sin_f32 v65, v61
    v_lshlrev_b32 v32, 16, v104
    v_and_b32 v33, 0xffff0000, v104
    v_exp_f32 v62, v62
    v_cvt_pk_bf16_f32 v116, v34, v35
    v_sub_f32 v36, v36, v32
    v_cos_f32 v66, v63
    v_sub_f32 v37, v37, v33
    v_cvt_pk_bf16_f32 v108, v36, v37
    v_sin_f32 v67, v63
    ds_read_b128 v[16:19], v7 offset:688
    s_waitcnt lgkmcnt(1)
    buffer_load_dword v75, v81, s[48:51], 0 offen offset:3072
    v_mul_f32 v32, v64, v60
    v_mul_f32 v33, v65, v60
    v_mul_f32 v20, v12, v4
    v_mul_f32 v34, v66, v62
    v_mul_f32 v35, -v67, v62
    v_mul_f32 v21, v13, v4
    v_mul_f32 v36, v32, v10
    v_mul_f32 v37, v33, v10
    v_mul_f32 v22, v12, v5
    v_cvt_pk_bf16_f32 v113, v34, v35
    v_fma_f32 v36, -v33, v11, v36
    v_mul_f32 v23, v13, v5
    v_fma_f32 v37, v32, v11, v37
    v_lshlrev_b32 v38, 16, v113
    v_exp_f32 v20, v20
    v_and_b32 v39, 0xffff0000, v113
    v_cvt_pk_bf16_f32 v105, v36, v37
    v_cos_f32 v24, v21
    v_sub_f32 v34, v34, v38
    v_sub_f32 v35, v35, v39
    v_sin_f32 v25, v21
    v_lshlrev_b32 v32, 16, v105
    v_and_b32 v33, 0xffff0000, v105
    v_exp_f32 v22, v22
    v_cvt_pk_bf16_f32 v117, v34, v35
    v_sub_f32 v36, v36, v32
    v_cos_f32 v26, v23
    v_sub_f32 v37, v37, v33
    v_cvt_pk_bf16_f32 v109, v36, v37
    v_sin_f32 v27, v23
    ds_read_b128 v[8:11], v7 offset:768
    s_waitcnt lgkmcnt(1)
    v_mul_f32 v32, v24, v20
    v_mul_f32 v33, v25, v20
    v_mul_f32 v60, v16, v4
    v_mul_f32 v34, v26, v22
    v_mul_f32 v35, -v27, v22
    v_mul_f32 v61, v17, v4
    v_mul_f32 v36, v32, v14
    v_mul_f32 v37, v33, v14
    v_mul_f32 v62, v16, v5
    v_cvt_pk_bf16_f32 v114, v34, v35
    v_fma_f32 v36, -v33, v15, v36
    v_mul_f32 v63, v17, v5
    v_fma_f32 v37, v32, v15, v37
    v_lshlrev_b32 v38, 16, v114
    v_exp_f32 v60, v60
    v_and_b32 v39, 0xffff0000, v114
    v_cvt_pk_bf16_f32 v106, v36, v37
    v_cos_f32 v64, v61
    v_sub_f32 v34, v34, v38
    v_sub_f32 v35, v35, v39
    v_sin_f32 v65, v61
    v_lshlrev_b32 v32, 16, v106
    v_and_b32 v33, 0xffff0000, v106
    v_exp_f32 v62, v62
    v_cvt_pk_bf16_f32 v118, v34, v35
    v_sub_f32 v36, v36, v32
    v_cos_f32 v66, v63
    v_sub_f32 v37, v37, v33
    v_cvt_pk_bf16_f32 v110, v36, v37
    v_sin_f32 v67, v63
    ds_read_b128 v[12:15], v7 offset:784
    s_waitcnt lgkmcnt(1)
    buffer_load_dword v76, v82, s[48:51], 0 offen offset:0
    v_mul_f32 v32, v64, v60
    v_mul_f32 v33, v65, v60
    v_mul_f32 v20, v8, v4
    v_mul_f32 v34, v66, v62
    v_mul_f32 v35, -v67, v62
    v_mul_f32 v21, v9, v4
    v_mul_f32 v36, v32, v18
    v_mul_f32 v37, v33, v18
    v_mul_f32 v22, v8, v5
    v_cvt_pk_bf16_f32 v115, v34, v35
    v_fma_f32 v36, -v33, v19, v36
    v_mul_f32 v23, v9, v5
    v_fma_f32 v37, v32, v19, v37
    v_lshlrev_b32 v38, 16, v115
    v_exp_f32 v20, v20
    v_and_b32 v39, 0xffff0000, v115
    v_cvt_pk_bf16_f32 v107, v36, v37
    v_cos_f32 v24, v21
    v_sub_f32 v34, v34, v38
    v_sub_f32 v35, v35, v39
    v_sin_f32 v25, v21
    v_lshlrev_b32 v32, 16, v107
    v_and_b32 v33, 0xffff0000, v107
    v_exp_f32 v22, v22
    v_cvt_pk_bf16_f32 v119, v34, v35
    v_sub_f32 v36, v36, v32
    v_cos_f32 v26, v23
    v_sub_f32 v37, v37, v33
    v_cvt_pk_bf16_f32 v111, v36, v37
    v_sin_f32 v27, v23
    v_mfma_f32_32x32x16_bf16 v[40:55], v[104:107], v[112:115], v[40:55]
    v_mfma_f32_32x32x16_bf16 v[40:55], v[104:107], v[116:119], v[40:55]
    v_mfma_f32_32x32x16_bf16 v[40:55], v[108:111], v[112:115], v[40:55]
    ds_read_b128 v[16:19], v7 offset:800
    s_waitcnt lgkmcnt(1)
    v_mul_f32 v32, v24, v20
    v_mul_f32 v33, v25, v20
    v_mul_f32 v60, v12, v4
    v_mul_f32 v34, v26, v22
    v_mul_f32 v35, -v27, v22
    v_mul_f32 v61, v13, v4
    v_mul_f32 v36, v32, v10
    v_mul_f32 v37, v33, v10
    v_mul_f32 v62, v12, v5
    v_cvt_pk_bf16_f32 v96, v34, v35
    v_fma_f32 v36, -v33, v11, v36
    v_mul_f32 v63, v13, v5
    v_fma_f32 v37, v32, v11, v37
    v_lshlrev_b32 v38, 16, v96
    v_exp_f32 v60, v60
    v_and_b32 v39, 0xffff0000, v96
    v_cvt_pk_bf16_f32 v88, v36, v37
    v_cos_f32 v64, v61
    v_sub_f32 v34, v34, v38
    v_sub_f32 v35, v35, v39
    v_sin_f32 v65, v61
    v_lshlrev_b32 v32, 16, v88
    v_and_b32 v33, 0xffff0000, v88
    v_exp_f32 v62, v62
    v_cvt_pk_bf16_f32 v100, v34, v35
    v_sub_f32 v36, v36, v32
    v_cos_f32 v66, v63
    v_sub_f32 v37, v37, v33
    v_cvt_pk_bf16_f32 v92, v36, v37
    v_sin_f32 v67, v63
    ds_read_b128 v[8:11], v7 offset:816
    s_waitcnt lgkmcnt(1)
    v_mul_f32 v32, v64, v60
    v_mul_f32 v33, v65, v60
    v_mul_f32 v20, v16, v4
    v_mul_f32 v34, v66, v62
    v_mul_f32 v35, -v67, v62
    v_mul_f32 v21, v17, v4
    v_mul_f32 v36, v32, v14
    v_mul_f32 v37, v33, v14
    v_mul_f32 v22, v16, v5
    v_cvt_pk_bf16_f32 v97, v34, v35
    v_fma_f32 v36, -v33, v15, v36
    v_mul_f32 v23, v17, v5
    v_fma_f32 v37, v32, v15, v37
    v_lshlrev_b32 v38, 16, v97
    v_exp_f32 v20, v20
    v_and_b32 v39, 0xffff0000, v97
    v_cvt_pk_bf16_f32 v89, v36, v37
    v_cos_f32 v24, v21
    v_sub_f32 v34, v34, v38
    v_sub_f32 v35, v35, v39
    v_sin_f32 v25, v21
    v_lshlrev_b32 v32, 16, v89
    v_and_b32 v33, 0xffff0000, v89
    v_exp_f32 v22, v22
    v_cvt_pk_bf16_f32 v101, v34, v35
    v_sub_f32 v36, v36, v32
    v_cos_f32 v26, v23
    v_sub_f32 v37, v37, v33
    v_cvt_pk_bf16_f32 v93, v36, v37
    v_sin_f32 v27, v23
    ds_read_b128 v[12:15], v7 offset:896
    s_waitcnt lgkmcnt(1)
    buffer_load_dword v77, v82, s[48:51], 0 offen offset:1024
    v_mul_f32 v32, v24, v20
    v_mul_f32 v33, v25, v20
    v_mul_f32 v60, v8, v4
    v_mul_f32 v34, v26, v22
    v_mul_f32 v35, -v27, v22
    v_mul_f32 v61, v9, v4
    v_mul_f32 v36, v32, v18
    v_mul_f32 v37, v33, v18
    v_mul_f32 v62, v8, v5
    v_cvt_pk_bf16_f32 v98, v34, v35
    v_fma_f32 v36, -v33, v19, v36
    v_mul_f32 v63, v9, v5
    v_fma_f32 v37, v32, v19, v37
    v_lshlrev_b32 v38, 16, v98
    v_exp_f32 v60, v60
    v_and_b32 v39, 0xffff0000, v98
    v_cvt_pk_bf16_f32 v90, v36, v37
    v_cos_f32 v64, v61
    v_sub_f32 v34, v34, v38
    v_sub_f32 v35, v35, v39
    v_sin_f32 v65, v61
    v_lshlrev_b32 v32, 16, v90
    v_and_b32 v33, 0xffff0000, v90
    v_exp_f32 v62, v62
    v_cvt_pk_bf16_f32 v102, v34, v35
    v_sub_f32 v36, v36, v32
    v_cos_f32 v66, v63
    v_sub_f32 v37, v37, v33
    v_cvt_pk_bf16_f32 v94, v36, v37
    v_sin_f32 v67, v63
    ds_read_b128 v[16:19], v7 offset:912
    s_waitcnt lgkmcnt(1)
    v_mul_f32 v32, v64, v60
    v_mul_f32 v33, v65, v60
    v_mul_f32 v20, v12, v4
    v_mul_f32 v34, v66, v62
    v_mul_f32 v35, -v67, v62
    v_mul_f32 v21, v13, v4
    v_mul_f32 v36, v32, v10
    v_mul_f32 v37, v33, v10
    v_mul_f32 v22, v12, v5
    v_cvt_pk_bf16_f32 v99, v34, v35
    v_fma_f32 v36, -v33, v11, v36
    v_mul_f32 v23, v13, v5
    v_fma_f32 v37, v32, v11, v37
    v_lshlrev_b32 v38, 16, v99
    v_exp_f32 v20, v20
    v_and_b32 v39, 0xffff0000, v99
    v_cvt_pk_bf16_f32 v91, v36, v37
    v_cos_f32 v24, v21
    v_sub_f32 v34, v34, v38
    v_sub_f32 v35, v35, v39
    v_sin_f32 v25, v21
    v_lshlrev_b32 v32, 16, v91
    v_and_b32 v33, 0xffff0000, v91
    v_exp_f32 v22, v22
    v_cvt_pk_bf16_f32 v103, v34, v35
    v_sub_f32 v36, v36, v32
    v_cos_f32 v26, v23
    v_sub_f32 v37, v37, v33
    v_cvt_pk_bf16_f32 v95, v36, v37
    v_sin_f32 v27, v23
    v_mfma_f32_32x32x16_bf16 v[40:55], v[88:91], v[96:99], v[40:55]
    v_mfma_f32_32x32x16_bf16 v[40:55], v[88:91], v[100:103], v[40:55]
    v_mfma_f32_32x32x16_bf16 v[40:55], v[92:95], v[96:99], v[40:55]
    ds_read_b128 v[8:11], v7 offset:928
    s_waitcnt lgkmcnt(1)
    buffer_load_dword v78, v82, s[48:51], 0 offen offset:2048
    v_mul_f32 v32, v24, v20
    v_mul_f32 v33, v25, v20
    v_mul_f32 v60, v16, v4
    v_mul_f32 v34, v26, v22
    v_mul_f32 v35, -v27, v22
    v_mul_f32 v61, v17, v4
    v_mul_f32 v36, v32, v14
    v_mul_f32 v37, v33, v14
    v_mul_f32 v62, v16, v5
    v_cvt_pk_bf16_f32 v112, v34, v35
    v_fma_f32 v36, -v33, v15, v36
    v_mul_f32 v63, v17, v5
    v_fma_f32 v37, v32, v15, v37
    v_lshlrev_b32 v38, 16, v112
    v_exp_f32 v60, v60
    v_and_b32 v39, 0xffff0000, v112
    v_cvt_pk_bf16_f32 v104, v36, v37
    v_cos_f32 v64, v61
    v_sub_f32 v34, v34, v38
    v_sub_f32 v35, v35, v39
    v_sin_f32 v65, v61
    v_lshlrev_b32 v32, 16, v104
    v_and_b32 v33, 0xffff0000, v104
    v_exp_f32 v62, v62
    v_cvt_pk_bf16_f32 v116, v34, v35
    v_sub_f32 v36, v36, v32
    v_cos_f32 v66, v63
    v_sub_f32 v37, v37, v33
    v_cvt_pk_bf16_f32 v108, v36, v37
    v_sin_f32 v67, v63
    ds_read_b128 v[12:15], v7 offset:944
    s_waitcnt lgkmcnt(1)
    v_mul_f32 v32, v64, v60
    v_mul_f32 v33, v65, v60
    v_mul_f32 v20, v8, v4
    v_mul_f32 v34, v66, v62
    v_mul_f32 v35, -v67, v62
    v_mul_f32 v21, v9, v4
    v_mul_f32 v36, v32, v18
    v_mul_f32 v37, v33, v18
    v_mul_f32 v22, v8, v5
    v_cvt_pk_bf16_f32 v113, v34, v35
    v_fma_f32 v36, -v33, v19, v36
    v_mul_f32 v23, v9, v5
    v_fma_f32 v37, v32, v19, v37
    v_lshlrev_b32 v38, 16, v113
    v_exp_f32 v20, v20
    v_and_b32 v39, 0xffff0000, v113
    v_cvt_pk_bf16_f32 v105, v36, v37
    v_cos_f32 v24, v21
    v_sub_f32 v34, v34, v38
    v_sub_f32 v35, v35, v39
    v_sin_f32 v25, v21
    v_lshlrev_b32 v32, 16, v105
    v_and_b32 v33, 0xffff0000, v105
    v_exp_f32 v22, v22
    v_cvt_pk_bf16_f32 v117, v34, v35
    v_sub_f32 v36, v36, v32
    v_cos_f32 v26, v23
    v_sub_f32 v37, v37, v33
    v_cvt_pk_bf16_f32 v109, v36, v37
    v_sin_f32 v27, v23
    s_waitcnt lgkmcnt(0)
    v_mul_f32 v32, v24, v20
    v_mul_f32 v33, v25, v20
    v_mul_f32 v60, v12, v4
    v_mul_f32 v34, v26, v22
    v_mul_f32 v35, -v27, v22
    v_mul_f32 v61, v13, v4
    v_mul_f32 v36, v32, v10
    v_mul_f32 v37, v33, v10
    v_mul_f32 v62, v12, v5
    v_cvt_pk_bf16_f32 v114, v34, v35
    v_fma_f32 v36, -v33, v11, v36
    v_mul_f32 v63, v13, v5
    v_fma_f32 v37, v32, v11, v37
    v_lshlrev_b32 v38, 16, v114
    v_exp_f32 v60, v60
    v_and_b32 v39, 0xffff0000, v114
    v_cvt_pk_bf16_f32 v106, v36, v37
    v_cos_f32 v64, v61
    v_sub_f32 v34, v34, v38
    v_sub_f32 v35, v35, v39
    v_sin_f32 v65, v61
    v_lshlrev_b32 v32, 16, v106
    v_and_b32 v33, 0xffff0000, v106
    v_exp_f32 v62, v62
    v_cvt_pk_bf16_f32 v118, v34, v35
    v_sub_f32 v36, v36, v32
    v_cos_f32 v66, v63
    v_sub_f32 v37, v37, v33
    v_cvt_pk_bf16_f32 v110, v36, v37
    v_sin_f32 v67, v63
    s_waitcnt lgkmcnt(0)
    buffer_load_dword v79, v82, s[48:51], 0 offen offset:3072
    v_mul_f32 v32, v64, v60
    v_mul_f32 v33, v65, v60
    v_mul_f32 v34, v66, v62
    v_mul_f32 v35, -v67, v62
    v_mul_f32 v36, v32, v14
    v_mul_f32 v37, v33, v14
    v_cvt_pk_bf16_f32 v115, v34, v35
    v_fma_f32 v36, -v33, v15, v36
    v_fma_f32 v37, v32, v15, v37
    v_lshlrev_b32 v38, 16, v115
    v_and_b32 v39, 0xffff0000, v115
    v_cvt_pk_bf16_f32 v107, v36, v37
    v_sub_f32 v34, v34, v38
    v_sub_f32 v35, v35, v39
    v_lshlrev_b32 v32, 16, v107
    v_and_b32 v33, 0xffff0000, v107
    v_cvt_pk_bf16_f32 v119, v34, v35
    v_sub_f32 v36, v36, v32
    v_sub_f32 v37, v37, v33
    v_cvt_pk_bf16_f32 v111, v36, v37
    v_mfma_f32_32x32x16_bf16 v[40:55], v[104:107], v[112:115], v[40:55]
    v_mfma_f32_32x32x16_bf16 v[40:55], v[104:107], v[116:119], v[40:55]
    v_mfma_f32_32x32x16_bf16 v[40:55], v[108:111], v[112:115], v[40:55]
    s_mul_i32 s17, s7, 4352
    s_add_u32 s17, s17, 4096
    v_lshlrev_b32 v20, 5, v2
    v_add_u32 v20, s17, v20
    v_lshlrev_b32 v21, 4, v2
    v_add_u32 v21, s17, v21
    v_lshlrev_b32 v22, 3, v2
    v_add_u32 v22, s17, v22
    v_lshlrev_b32 v23, 2, v2
    v_add_u32 v23, s17, v23
    v_cmp_eq_u32 vcc, 1, v3
    v_add_u32 v24, 0, v20
    v_add_u32 v25, 16, v20
    v_cndmask_b32 v24, v24, v25, vcc
    ds_write_b32 v24, v40
    v_add_u32 v24, 4, v20
    v_add_u32 v25, 20, v20
    v_cndmask_b32 v24, v24, v25, vcc
    ds_write_b32 v24, v41
    v_add_u32 v24, 8, v20
    v_add_u32 v25, 24, v20
    v_cndmask_b32 v24, v24, v25, vcc
    ds_write_b32 v24, v42
    v_add_u32 v24, 12, v20
    v_add_u32 v25, 28, v20
    v_cndmask_b32 v24, v24, v25, vcc
    ds_write_b32 v24, v43
    v_add_u32 v24, 1536, v21
    v_add_u32 v25, 2560, v22
    v_cndmask_b32 v24, v24, v25, vcc
    ds_write_b32 v24, v44
    v_add_u32 v24, 1540, v21
    v_add_u32 v25, 2564, v22
    v_cndmask_b32 v24, v24, v25, vcc
    ds_write_b32 v24, v45
    v_add_u32 v24, 1544, v21
    v_add_u32 v25, 2816, v22
    v_cndmask_b32 v24, v24, v25, vcc
    ds_write_b32 v24, v46
    v_add_u32 v24, 1548, v21
    v_add_u32 v25, 2820, v22
    v_cndmask_b32 v24, v24, v25, vcc
    ds_write_b32 v24, v47
    v_add_u32 v24, 3584, v23
    v_add_u32 v25, 4096, v23
    v_cndmask_b32 v24, v24, v25, vcc
    ds_write_b32 v24, v48
    v_add_u32 v24, 3712, v23
    v_add_u32 v25, 2048, v21
    v_cndmask_b32 v24, v24, v25, vcc
    ds_write_b32 v24, v49
    v_add_u32 v24, 3840, v23
    v_add_u32 v25, 3072, v22
    v_cndmask_b32 v24, v24, v25, vcc
    ds_write_b32 v24, v50
    v_add_u32 v24, 3968, v23
    v_mov_b32 v25, s17
    v_add_u32 v25, 4336, v25
    v_cndmask_b32 v24, v24, v25, vcc
    ds_write_b32 v24, v51
    s_waitcnt lgkmcnt(0)
    s_barrier
    s_lshl_b32 s17, s16, 6
    v_add_u32 v3, s17, v1
    s_mul_i32 s19, s15, 8704
    s_add_u32 s19, s19, 4096
    s_mul_i32 s18, s15, 8960
    s_add_u32 s18, s18, 37184
    v_or_b32 v4, 1, v3
    v_ffbh_u32 v4, v4
    v_sub_u32 v4, 27, v4
    v_max_i32 v4, 0, v4
    v_min_u32 v5, 1, v4
    v_lshlrev_b32 v6, v4, 1
    v_lshrrev_b32 v6, 1, v6
    v_sub_u32 v6, v6, v5
    v_lshlrev_b32 v7, 10, v4
    v_add_u32 v7, s19, v7
    v_lshlrev_b32 v8, 3, v3
    v_add_u32 v9, 7, v8
    v_bfe_u32 v10, v9, v4, v5
    v_add3_u32 v9, v9, v6, v10
    v_lshrrev_b32 v9, v4, v9
    v_lshl_add_u32 v9, v9, 2, v7
    ds_read2st64_b32 v[16:17], v9 offset0:0 offset1:17
    v_add_u32 v9, 6, v8
    v_bfe_u32 v10, v9, v4, v5
    v_add3_u32 v9, v9, v6, v10
    v_lshrrev_b32 v9, v4, v9
    v_lshl_add_u32 v9, v9, 2, v7
    ds_read2st64_b32 v[18:19], v9 offset0:0 offset1:17
    v_add_u32 v9, 5, v8
    v_bfe_u32 v10, v9, v4, v5
    v_add3_u32 v9, v9, v6, v10
    v_lshrrev_b32 v9, v4, v9
    v_lshl_add_u32 v9, v9, 2, v7
    ds_read2st64_b32 v[20:21], v9 offset0:0 offset1:17
    v_add_u32 v9, 4, v8
    v_bfe_u32 v10, v9, v4, v5
    v_add3_u32 v9, v9, v6, v10
    v_lshrrev_b32 v9, v4, v9
    v_lshl_add_u32 v9, v9, 2, v7
    ds_read2st64_b32 v[22:23], v9 offset0:0 offset1:17
    v_add_u32 v9, 3, v8
    v_bfe_u32 v10, v9, v4, v5
    v_add3_u32 v9, v9, v6, v10
    v_lshrrev_b32 v9, v4, v9
    v_lshl_add_u32 v9, v9, 2, v7
    ds_read2st64_b32 v[24:25], v9 offset0:0 offset1:17
    v_add_u32 v9, 2, v8
    v_bfe_u32 v10, v9, v4, v5
    v_add3_u32 v9, v9, v6, v10
    v_lshrrev_b32 v9, v4, v9
    v_lshl_add_u32 v9, v9, 2, v7
    ds_read2st64_b32 v[26:27], v9 offset0:0 offset1:17
    v_add_u32 v9, 1, v8
    v_bfe_u32 v10, v9, v4, v5
    v_add3_u32 v9, v9, v6, v10
    v_lshrrev_b32 v9, v4, v9
    v_lshl_add_u32 v9, v9, 2, v7
    ds_read2st64_b32 v[28:29], v9 offset0:0 offset1:17
    v_add_u32 v9, 0, v8
    v_bfe_u32 v10, v9, v4, v5
    v_add3_u32 v9, v9, v6, v10
    v_lshrrev_b32 v9, v4, v9
    v_lshl_add_u32 v9, v9, 2, v7
    ds_read2st64_b32 v[30:31], v9 offset0:0 offset1:17
    v_subrev_u32 v11, 1, v3
    v_max_i32 v11, 0, v11
    v_or_b32 v4, 1, v11
    v_ffbh_u32 v4, v4
    v_sub_u32 v4, 27, v4
    v_max_i32 v4, 0, v4
    v_min_u32 v5, 1, v4
    v_lshlrev_b32 v6, v4, 1
    v_lshrrev_b32 v6, 1, v6
    v_sub_u32 v6, v6, v5
    v_lshlrev_b32 v7, 10, v4
    v_add_u32 v7, s19, v7
    v_add_u32 v9, -1, v8
    v_bfe_u32 v10, v9, v4, v5
    v_add3_u32 v9, v9, v6, v10
    v_lshrrev_b32 v9, v4, v9
    v_lshl_add_u32 v9, v9, 2, v7
    ds_read2st64_b32 v[32:33], v9 offset0:0 offset1:17
    v_lshlrev_b32 v9, 4, v3
    v_sub_u32 v9, s18, v9
    v_cmp_ne_u32 vcc, 0, v3
    s_waitcnt lgkmcnt(8)
    v_add_f32 v16, v16, v17
    s_waitcnt lgkmcnt(7)
    v_add_f32 v18, v18, v19
    s_waitcnt lgkmcnt(6)
    v_add_f32 v20, v20, v21
    s_waitcnt lgkmcnt(5)
    v_add_f32 v22, v22, v23
    s_waitcnt lgkmcnt(4)
    v_add_f32 v24, v24, v25
    s_waitcnt lgkmcnt(3)
    v_add_f32 v26, v26, v27
    s_waitcnt lgkmcnt(2)
    v_add_f32 v28, v28, v29
    s_waitcnt lgkmcnt(1)
    v_add_f32 v30, v30, v31
    s_waitcnt lgkmcnt(0)
    v_add_f32 v32, v32, v33
    v_cndmask_b32 v32, 0, v32, vcc
    v_cvt_pk_bf16_f32 v40, v16, v18
    v_cvt_pk_bf16_f32 v41, v20, v22
    v_cvt_pk_bf16_f32 v42, v24, v26
    v_cvt_pk_bf16_f32 v43, v28, v30
    v_cvt_pk_bf16_f32 v44, v32, v32
    v_lshlrev_b32 v60, 16, v40
    v_and_b32 v61, 0xffff0000, v40
    v_sub_f32 v60, v16, v60
    v_sub_f32 v61, v18, v61
    v_cvt_pk_bf16_f32 v46, v60, v61
    v_lshlrev_b32 v60, 16, v41
    v_and_b32 v61, 0xffff0000, v41
    v_sub_f32 v60, v20, v60
    v_sub_f32 v61, v22, v61
    v_cvt_pk_bf16_f32 v47, v60, v61
    v_lshlrev_b32 v60, 16, v42
    v_and_b32 v61, 0xffff0000, v42
    v_sub_f32 v60, v24, v60
    v_sub_f32 v61, v26, v61
    v_cvt_pk_bf16_f32 v48, v60, v61
    v_lshlrev_b32 v60, 16, v43
    v_and_b32 v61, 0xffff0000, v43
    v_sub_f32 v60, v28, v60
    v_sub_f32 v61, v30, v61
    v_cvt_pk_bf16_f32 v49, v60, v61
    v_lshlrev_b32 v60, 16, v44
    v_sub_f32 v60, v32, v60
    v_cvt_pk_bf16_f32 v50, v60, v60
    v_alignbit_b32 v52, v41, v40, 16
    v_alignbit_b32 v53, v42, v41, 16
    v_alignbit_b32 v54, v43, v42, 16
    v_alignbit_b32 v55, v44, v43, 16
    v_alignbit_b32 v56, v47, v46, 16
    v_alignbit_b32 v57, v48, v47, 16
    v_alignbit_b32 v58, v49, v48, 16
    v_alignbit_b32 v59, v50, v49, 16
    ds_write_b128 v9, v[40:43] offset:2160
    ds_write_b128 v9, v[52:55] offset:4400
    ds_write_b128 v9, v[46:49] offset:6640
    ds_write_b128 v9, v[56:59] offset:8880
    s_waitcnt vmcnt(0)
    s_mov_b32 s8, 0x05040100
    s_mov_b32 s9, 0x07060302
    v_lshrrev_b32 v128, 2, v0
    v_mul_u32_u24 v128, 80, v128
    v_and_b32 v100, 3, v0
    v_lshl_add_u32 v128, v100, 4, v128
    v_perm_b32 v100, v73, v72, s8
    v_perm_b32 v101, v75, v74, s8
    v_perm_b32 v102, v77, v76, s8
    v_perm_b32 v103, v79, v78, s8
    ds_write_b128 v128, v[100:103] offset:24224
    v_perm_b32 v104, v73, v72, s9
    v_perm_b32 v105, v75, v74, s9
    v_perm_b32 v106, v77, v76, s9
    v_perm_b32 v107, v79, v78, s9
    ds_write_b128 v128, v[104:107] offset:32064
    s_mov_b32 s56, s36
    s_and_b32 s57, s37, 0xffff
    s_mov_b32 s58, 1409024
    s_mov_b32 s59, 0x00020000
    v_lshrrev_b32 v104, 5, v1
    v_bfe_u32 v106, v1, 2, 2
    v_lshl_add_u32 v104, v104, 2, v106
    v_lshlrev_b32 v104, 10, v104
    v_bfe_u32 v106, v1, 4, 1
    v_lshl_add_u32 v104, v106, 6, v104
    v_and_b32 v106, 3, v1
    v_lshl_add_u32 v104, v106, 4, v104
    v_lshlrev_b32 v105, 4, v1
    v_add_u32 v105, 10485760, v105
    s_lshl_b32 s8, s2, 2
    s_add_u32 s8, s8, s7
    s_add_u32 s28, s8, 0
    s_cmp_lt_u32 s28, 1408
    s_cselect_b32 s28, s28, s8
    s_lshr_b32 s9, s28, 3
    s_mul_i32 s10, s9, 373
    s_lshr_b32 s10, s10, 12
    s_mul_i32 s11, s10, 11
    s_sub_u32 s9, s9, s11
    s_lshl_b32 s9, s9, 6
    s_and_b32 s11, s10, 1
    s_mul_i32 s11, s11, 688
    s_add_u32 s9, s9, s11
    s_and_b32 s11, s28, 7
    s_lshl_b32 s11, s11, 3
    s_add_u32 s9, s9, s11
    s_lshl_b32 s9, s9, 10
    s_lshr_b32 s10, s10, 1
    s_lshl_b32 s10, s10, 7
    s_add_u32 s9, s9, s10
    buffer_load_dwordx4 v[96:99], v104, s[56:59], s9 offen
    s_lshl_b32 s28, s28, 10
    s_add_u32 s29, s8, 1024
    s_cmp_lt_u32 s29, 1408
    s_cselect_b32 s29, s29, s8
    s_lshr_b32 s9, s29, 3
    s_mul_i32 s10, s9, 373
    s_lshr_b32 s10, s10, 12
    s_mul_i32 s11, s10, 11
    s_sub_u32 s9, s9, s11
    s_lshl_b32 s9, s9, 6
    s_and_b32 s11, s10, 1
    s_mul_i32 s11, s11, 688
    s_add_u32 s9, s9, s11
    s_and_b32 s11, s29, 7
    s_lshl_b32 s11, s11, 3
    s_add_u32 s9, s9, s11
    s_lshl_b32 s9, s9, 10
    s_lshr_b32 s10, s10, 1
    s_lshl_b32 s10, s10, 7
    s_add_u32 s9, s9, s10
    buffer_load_dwordx4 v[100:103], v104, s[56:59], s9 offen
    s_lshl_b32 s29, s29, 10
    v_and_b32 v2, 31, v1
    v_lshrrev_b32 v3, 5, v1
    v_and_b32 v4, 1, v2
    v_cmp_eq_u32 vcc, 1, v4
    v_mov_b32 v4, 2300
    s_nop 0
    v_cndmask_b32 v4, v4, 62, vcc
    v_lshlrev_b32 v5, 1, v2
    v_sub_u32 v4, v4, v5
    v_lshl_add_u32 v4, v3, 4, v4
    s_lshl_b32 s17, s16, 5
    s_add_u32 s17, s17, s18
    v_add_u32 v4, s17, v4
    v_add_u32 v5, 1024, v4
    v_add_u32 v6, 2048, v4
    v_add_u32 v7, 4480, v4
    v_add_u32 v8, 5504, v4
    v_add_u32 v9, 6528, v4
    v_mul_u32_u24 v10, 80, v2
    v_lshl_add_u32 v10, v3, 4, v10
    s_mul_i32 s20, s15, 7840
    s_add_u32 s20, s20, 21504
    s_lshl_b32 s17, s16, 5
    s_add_u32 s17, s17, s20
    s_add_u32 s17, s17, 80
    v_add_u32 v10, s17, v10
    v_bfe_u32 v11, v1, 2, 2
    v_bfe_u32 v12, v1, 4, 1
    v_add_u32 v11, v11, v12
    v_lshl_add_u32 v11, v3, 3, v11
    v_lshlrev_b32 v11, 5, v11
    v_and_b32 v12, 3, v1
    v_lshl_add_u32 v11, v12, 3, v11
    s_mul_i32 s21, s15, 8320
    s_add_u32 s21, s21, 55104
    s_mul_i32 s17, s16, 4160
    s_add_u32 s17, s17, s21
    v_add_u32 v11, s17, v11
    v_lshlrev_b32 v12, 2, v2
    v_sub_u32 v12, 124, v12
    v_lshl_add_u32 v12, v3, 4, v12
    s_lshl_b32 s26, s15, 10
    s_add_u32 s26, s26, 71744
    s_lshl_b32 s17, s16, 9
    s_add_u32 s17, s17, s26
    v_add_u32 v12, s17, v12
    v_mov_b32 v64, 0
    v_mov_b32 v65, 0
    v_mov_b32 v66, 0
    v_mov_b32 v67, 0
    v_mov_b32 v68, 0
    v_mov_b32 v69, 0
    v_mov_b32 v70, 0
    v_mov_b32 v71, 0
    v_mov_b32 v72, 0
    v_mov_b32 v73, 0
    v_mov_b32 v74, 0
    v_mov_b32 v75, 0
    v_mov_b32 v76, 0
    v_mov_b32 v77, 0
    v_mov_b32 v78, 0
    v_mov_b32 v79, 0
    v_mov_b32 v80, 0
    v_mov_b32 v81, 0
    v_mov_b32 v82, 0
    v_mov_b32 v83, 0
    v_mov_b32 v84, 0
    v_mov_b32 v85, 0
    v_mov_b32 v86, 0
    v_mov_b32 v87, 0
    v_mov_b32 v88, 0
    v_mov_b32 v89, 0
    v_mov_b32 v90, 0
    v_mov_b32 v91, 0
    v_mov_b32 v92, 0
    v_mov_b32 v93, 0
    v_mov_b32 v94, 0
    v_mov_b32 v95, 0
    s_waitcnt lgkmcnt(0)
    s_barrier
    s_setprio 1
    ds_read2_b32 v[16:17], v6 offset0:16 offset1:17
    ds_read2_b32 v[18:19], v6 offset0:18 offset1:19
    ds_read2_b32 v[20:21], v9 offset0:16 offset1:17
    ds_read2_b32 v[22:23], v9 offset0:18 offset1:19
    ds_read_b128 v[24:27], v10 offset:2640
    ds_read_b128 v[28:31], v10 offset:5200
    ds_read2_b32 v[32:33], v6 offset0:0 offset1:1
    ds_read2_b32 v[34:35], v6 offset0:2 offset1:3
    ds_read2_b32 v[36:37], v9 offset0:0 offset1:1
    ds_read2_b32 v[38:39], v9 offset0:2 offset1:3
    ds_read_b128 v[40:43], v10 offset:2560
    ds_read_b128 v[44:47], v10 offset:5120
    ds_read2_b32 v[48:49], v5 offset0:240 offset1:241
    ds_read2_b32 v[50:51], v5 offset0:242 offset1:243
    ds_read2_b32 v[52:53], v8 offset0:240 offset1:241
    ds_read2_b32 v[54:55], v8 offset0:242 offset1:243
    ds_read_b128 v[56:59], v10 offset:2480
    ds_read_b128 v[60:63], v10 offset:5040
    s_waitcnt lgkmcnt(12)
    v_mfma_f32_32x32x16_bf16 v[80:95], v[16:19], v[28:31], v[80:95]
    s_lshl_b32 s27, s16, 6
    v_add_u32 v218, s27, v1
    v_add_u32 v216, 132, v218
    v_lshrrev_b32 v217, 2, v216
    v_mfma_f32_32x32x16_bf16 v[64:79], v[16:19], v[24:27], v[64:79]
    v_mul_u32_u24 v217, 80, v217
    v_and_b32 v216, 3, v216
    v_lshl_add_u32 v217, v216, 4, v217
    v_add_u32 v148, s20, v217
    v_mfma_f32_32x32x16_bf16 v[80:95], v[20:23], v[28:31], v[80:95]
    ds_read_b128 v[152:155], v148
    v_add_u32 v216, 133, v218
    v_lshrrev_b32 v217, 2, v216
    v_mul_u32_u24 v217, 80, v217
    v_mfma_f32_32x32x16_bf16 v[64:79], v[20:23], v[24:27], v[64:79]
    v_and_b32 v216, 3, v216
    v_lshl_add_u32 v217, v216, 4, v217
    v_add_u32 v149, s20, v217
    ds_read_b128 v[156:159], v149
    ds_read2_b32 v[16:17], v5 offset0:224 offset1:225
    ds_read2_b32 v[18:19], v5 offset0:226 offset1:227
    ds_read2_b32 v[20:21], v8 offset0:224 offset1:225
    ds_read2_b32 v[22:23], v8 offset0:226 offset1:227
    ds_read_b128 v[24:27], v10 offset:2400
    ds_read_b128 v[28:31], v10 offset:4960
    s_waitcnt lgkmcnt(14)
    v_mfma_f32_32x32x16_bf16 v[80:95], v[32:35], v[44:47], v[80:95]
    v_add_u32 v216, 134, v218
    v_lshrrev_b32 v217, 2, v216
    v_mul_u32_u24 v217, 80, v217
    v_and_b32 v216, 3, v216
    v_mfma_f32_32x32x16_bf16 v[64:79], v[32:35], v[40:43], v[64:79]
    v_lshl_add_u32 v217, v216, 4, v217
    v_add_u32 v150, s20, v217
    ds_read_b128 v[160:163], v150
    v_add_u32 v216, 135, v218
    v_mfma_f32_32x32x16_bf16 v[80:95], v[36:39], v[44:47], v[80:95]
    v_lshrrev_b32 v217, 2, v216
    v_mul_u32_u24 v217, 80, v217
    v_and_b32 v216, 3, v216
    v_lshl_add_u32 v217, v216, 4, v217
    v_mfma_f32_32x32x16_bf16 v[64:79], v[36:39], v[40:43], v[64:79]
    v_add_u32 v151, s20, v217
    ds_read_b128 v[164:167], v151
    v_lshlrev_b32 v218, 4, v218
    v_add_u32 v218, s21, v218
    ds_read2_b32 v[32:33], v5 offset0:208 offset1:209
    ds_read2_b32 v[34:35], v5 offset0:210 offset1:211
    ds_read2_b32 v[36:37], v8 offset0:208 offset1:209
    ds_read2_b32 v[38:39], v8 offset0:210 offset1:211
    ds_read_b128 v[40:43], v10 offset:2320
    ds_read_b128 v[44:47], v10 offset:4880
    s_waitcnt lgkmcnt(15)
    v_mfma_f32_32x32x16_bf16 v[80:95], v[48:51], v[60:63], v[80:95]
    s_waitcnt lgkmcnt(15)
    v_and_b32 v168, 0xffff0000, v154
    v_lshlrev_b32 v169, 16, v155
    v_and_b32 v170, 0xffff0000, v155
    v_mfma_f32_32x32x16_bf16 v[64:79], v[48:51], v[56:59], v[64:79]
    s_waitcnt lgkmcnt(14)
    v_lshlrev_b32 v171, 16, v156
    v_and_b32 v172, 0xffff0000, v156
    v_lshlrev_b32 v173, 16, v157
    v_mfma_f32_32x32x16_bf16 v[80:95], v[52:55], v[60:63], v[80:95]
    v_and_b32 v174, 0xffff0000, v157
    v_lshlrev_b32 v175, 16, v158
    v_and_b32 v176, 0xffff0000, v158
    v_lshlrev_b32 v177, 16, v159
    v_mfma_f32_32x32x16_bf16 v[64:79], v[52:55], v[56:59], v[64:79]
    v_and_b32 v178, 0xffff0000, v159
    s_waitcnt lgkmcnt(7)
    v_lshlrev_b32 v179, 16, v160
    v_and_b32 v180, 0xffff0000, v160
    ds_read2_b32 v[48:49], v5 offset0:192 offset1:193
    ds_read2_b32 v[50:51], v5 offset0:194 offset1:195
    ds_read2_b32 v[52:53], v8 offset0:192 offset1:193
    ds_read2_b32 v[54:55], v8 offset0:194 offset1:195
    ds_read_b128 v[56:59], v10 offset:2240
    ds_read_b128 v[60:63], v10 offset:4800
    s_waitcnt lgkmcnt(14)
    v_mfma_f32_32x32x16_bf16 v[80:95], v[16:19], v[28:31], v[80:95]
    v_lshlrev_b32 v181, 16, v161
    v_and_b32 v182, 0xffff0000, v161
    v_lshlrev_b32 v183, 16, v162
    v_and_b32 v184, 0xffff0000, v162
    v_mfma_f32_32x32x16_bf16 v[64:79], v[16:19], v[24:27], v[64:79]
    v_lshlrev_b32 v185, 16, v163
    v_and_b32 v186, 0xffff0000, v163
    s_waitcnt lgkmcnt(12)
    v_lshlrev_b32 v187, 16, v164
    v_mfma_f32_32x32x16_bf16 v[80:95], v[20:23], v[28:31], v[80:95]
    v_and_b32 v188, 0xffff0000, v164
    v_lshlrev_b32 v189, 16, v165
    v_and_b32 v190, 0xffff0000, v165
    v_add_f32 v192, v175, v176
    v_mfma_f32_32x32x16_bf16 v[64:79], v[20:23], v[24:27], v[64:79]
    v_add_f32 v192, v192, v177
    v_add_f32 v192, v192, v178
    v_add_f32 v192, v192, v179
    v_add_f32 v192, v192, v180
    ds_read2_b32 v[16:17], v5 offset0:176 offset1:177
    ds_read2_b32 v[18:19], v5 offset0:178 offset1:179
    ds_read2_b32 v[20:21], v8 offset0:176 offset1:177
    ds_read2_b32 v[22:23], v8 offset0:178 offset1:179
    ds_read_b128 v[24:27], v10 offset:2160
    ds_read_b128 v[28:31], v10 offset:4720
    s_waitcnt lgkmcnt(12)
    v_mfma_f32_32x32x16_bf16 v[80:95], v[32:35], v[44:47], v[80:95]
    v_add_f32 v192, v192, v181
    v_add_f32 v192, v192, v182
    v_add_f32 v192, v192, v183
    v_sub_f32 v216, v184, v175
    v_mfma_f32_32x32x16_bf16 v[64:79], v[32:35], v[40:43], v[64:79]
    v_add_f32 v193, v192, v216
    v_sub_f32 v216, v185, v176
    v_add_f32 v194, v193, v216
    v_sub_f32 v216, v186, v177
    v_mfma_f32_32x32x16_bf16 v[80:95], v[36:39], v[44:47], v[80:95]
    v_add_f32 v195, v194, v216
    v_sub_f32 v216, v187, v178
    v_add_f32 v196, v195, v216
    v_sub_f32 v216, v188, v179
    v_mfma_f32_32x32x16_bf16 v[64:79], v[36:39], v[40:43], v[64:79]
    v_add_f32 v197, v196, v216
    v_sub_f32 v216, v189, v180
    v_add_f32 v198, v197, v216
    v_sub_f32 v216, v190, v181
    ds_read2_b32 v[32:33], v5 offset0:160 offset1:161
    ds_read2_b32 v[34:35], v5 offset0:162 offset1:163
    ds_read2_b32 v[36:37], v8 offset0:160 offset1:161
    ds_read2_b32 v[38:39], v8 offset0:162 offset1:163
    ds_read_b128 v[40:43], v10 offset:2080
    ds_read_b128 v[44:47], v10 offset:4640
    s_waitcnt lgkmcnt(12)
    v_mfma_f32_32x32x16_bf16 v[80:95], v[48:51], v[60:63], v[80:95]
    v_add_f32 v199, v198, v216
    v_cvt_pk_bf16_f32 v208, v192, v193
    v_lshlrev_b32 v216, 16, v208
    v_and_b32 v217, 0xffff0000, v208
    v_mfma_f32_32x32x16_bf16 v[64:79], v[48:51], v[56:59], v[64:79]
    v_sub_f32 v216, v192, v216
    v_sub_f32 v217, v193, v217
    v_cvt_pk_bf16_f32 v212, v216, v217
    v_cvt_pk_bf16_f32 v209, v194, v195
    v_mfma_f32_32x32x16_bf16 v[80:95], v[52:55], v[60:63], v[80:95]
    v_lshlrev_b32 v216, 16, v209
    v_and_b32 v217, 0xffff0000, v209
    v_sub_f32 v216, v194, v216
    v_sub_f32 v217, v195, v217
    v_mfma_f32_32x32x16_bf16 v[64:79], v[52:55], v[56:59], v[64:79]
    v_cvt_pk_bf16_f32 v213, v216, v217
    v_cvt_pk_bf16_f32 v210, v196, v197
    v_lshlrev_b32 v216, 16, v210
    v_and_b32 v217, 0xffff0000, v210
    ds_read2_b32 v[48:49], v5 offset0:144 offset1:145
    ds_read2_b32 v[50:51], v5 offset0:146 offset1:147
    ds_read2_b32 v[52:53], v8 offset0:144 offset1:145
    ds_read2_b32 v[54:55], v8 offset0:146 offset1:147
    ds_read_b128 v[56:59], v10 offset:2000
    ds_read_b128 v[60:63], v10 offset:4560
    s_waitcnt lgkmcnt(12)
    v_mfma_f32_32x32x16_bf16 v[80:95], v[16:19], v[28:31], v[80:95]
    v_sub_f32 v216, v196, v216
    v_sub_f32 v217, v197, v217
    v_cvt_pk_bf16_f32 v214, v216, v217
    v_cvt_pk_bf16_f32 v211, v198, v199
    v_mfma_f32_32x32x16_bf16 v[64:79], v[16:19], v[24:27], v[64:79]
    v_lshlrev_b32 v216, 16, v211
    v_and_b32 v217, 0xffff0000, v211
    v_sub_f32 v216, v198, v216
    v_sub_f32 v217, v199, v217
    v_mfma_f32_32x32x16_bf16 v[80:95], v[20:23], v[28:31], v[80:95]
    v_cvt_pk_bf16_f32 v215, v216, v217
    ds_write_b128 v218, v[208:211] offset:32
    ds_write_b128 v218, v[212:215] offset:2112
    s_waitcnt lgkmcnt(0)
    v_mfma_f32_32x32x16_bf16 v[64:79], v[20:23], v[24:27], v[64:79]
    v_add_f32 v200, v168, v169
    v_add_f32 v200, v200, v170
    v_add_f32 v200, v200, v171
    v_add_f32 v200, v200, v172
    ds_read2_b32 v[16:17], v5 offset0:128 offset1:129
    ds_read2_b32 v[18:19], v5 offset0:130 offset1:131
    ds_read2_b32 v[20:21], v8 offset0:128 offset1:129
    ds_read2_b32 v[22:23], v8 offset0:130 offset1:131
    ds_read_b128 v[24:27], v10 offset:1920
    ds_read_b128 v[28:31], v10 offset:4480
    s_waitcnt lgkmcnt(14)
    v_mfma_f32_32x32x16_bf16 v[80:95], v[32:35], v[44:47], v[80:95]
    v_add_f32 v200, v200, v173
    v_add_f32 v200, v200, v174
    v_sub_f32 v216, v175, v168
    v_add_f32 v201, v200, v216
    v_mfma_f32_32x32x16_bf16 v[64:79], v[32:35], v[40:43], v[64:79]
    v_sub_f32 v216, v176, v169
    v_add_f32 v202, v201, v216
    v_sub_f32 v216, v177, v170
    v_add_f32 v203, v202, v216
    v_mfma_f32_32x32x16_bf16 v[80:95], v[36:39], v[44:47], v[80:95]
    v_sub_f32 v216, v178, v171
    v_add_f32 v204, v203, v216
    v_sub_f32 v216, v179, v172
    v_add_f32 v205, v204, v216
    v_mfma_f32_32x32x16_bf16 v[64:79], v[36:39], v[40:43], v[64:79]
    v_sub_f32 v216, v180, v173
    v_add_f32 v206, v205, v216
    v_sub_f32 v216, v181, v174
    v_add_f32 v207, v206, v216
    ds_read2_b32 v[32:33], v5 offset0:112 offset1:113
    ds_read2_b32 v[34:35], v5 offset0:114 offset1:115
    ds_read2_b32 v[36:37], v8 offset0:112 offset1:113
    ds_read2_b32 v[38:39], v8 offset0:114 offset1:115
    ds_read_b128 v[40:43], v10 offset:1840
    ds_read_b128 v[44:47], v10 offset:4400
    s_waitcnt lgkmcnt(14)
    v_mfma_f32_32x32x16_bf16 v[80:95], v[48:51], v[60:63], v[80:95]
    v_cvt_pk_bf16_f32 v208, v200, v201
    v_lshlrev_b32 v216, 16, v208
    v_and_b32 v217, 0xffff0000, v208
    v_sub_f32 v216, v200, v216
    v_mfma_f32_32x32x16_bf16 v[64:79], v[48:51], v[56:59], v[64:79]
    v_sub_f32 v217, v201, v217
    v_cvt_pk_bf16_f32 v212, v216, v217
    v_cvt_pk_bf16_f32 v209, v202, v203
    v_lshlrev_b32 v216, 16, v209
    v_mfma_f32_32x32x16_bf16 v[80:95], v[52:55], v[60:63], v[80:95]
    v_and_b32 v217, 0xffff0000, v209
    v_sub_f32 v216, v202, v216
    v_sub_f32 v217, v203, v217
    v_cvt_pk_bf16_f32 v213, v216, v217
    v_mfma_f32_32x32x16_bf16 v[64:79], v[52:55], v[56:59], v[64:79]
    v_cvt_pk_bf16_f32 v210, v204, v205
    v_lshlrev_b32 v216, 16, v210
    v_and_b32 v217, 0xffff0000, v210
    v_sub_f32 v216, v204, v216
    ds_read2_b32 v[48:49], v5 offset0:96 offset1:97
    ds_read2_b32 v[50:51], v5 offset0:98 offset1:99
    ds_read2_b32 v[52:53], v8 offset0:96 offset1:97
    ds_read2_b32 v[54:55], v8 offset0:98 offset1:99
    ds_read_b128 v[56:59], v10 offset:1760
    ds_read_b128 v[60:63], v10 offset:4320
    s_waitcnt lgkmcnt(12)
    v_mfma_f32_32x32x16_bf16 v[80:95], v[16:19], v[28:31], v[80:95]
    v_sub_f32 v217, v205, v217
    v_cvt_pk_bf16_f32 v214, v216, v217
    v_cvt_pk_bf16_f32 v211, v206, v207
    v_lshlrev_b32 v216, 16, v211
    v_mfma_f32_32x32x16_bf16 v[64:79], v[16:19], v[24:27], v[64:79]
    v_and_b32 v217, 0xffff0000, v211
    v_sub_f32 v216, v206, v216
    v_sub_f32 v217, v207, v217
    v_cvt_pk_bf16_f32 v215, v216, v217
    v_mfma_f32_32x32x16_bf16 v[80:95], v[20:23], v[28:31], v[80:95]
    ds_write_b128 v218, v[208:211] offset:4192
    ds_write_b128 v218, v[212:215] offset:6272
    s_waitcnt lgkmcnt(0)
    v_cmp_gt_u32 s[22:23], 8, v1
    v_mfma_f32_32x32x16_bf16 v[64:79], v[20:23], v[24:27], v[64:79]
    v_subrev_u32 v156, 8, v1
    v_cmp_gt_u32 s[24:25], 32, v156
    v_lshrrev_b32 v157, 4, v156
    v_and_b32 v157, 3, v157
    ds_read2_b32 v[16:17], v5 offset0:80 offset1:81
    ds_read2_b32 v[18:19], v5 offset0:82 offset1:83
    ds_read2_b32 v[20:21], v8 offset0:80 offset1:81
    ds_read2_b32 v[22:23], v8 offset0:82 offset1:83
    ds_read_b128 v[24:27], v10 offset:1680
    ds_read_b128 v[28:31], v10 offset:4240
    s_waitcnt lgkmcnt(14)
    v_mfma_f32_32x32x16_bf16 v[80:95], v[32:35], v[44:47], v[80:95]
    v_and_b32 v156, 15, v156
    v_lshlrev_b32 v152, 3, v157
    v_lshlrev_b32 v198, 7, v156
    v_sub_u32 v152, v152, v198
    v_mfma_f32_32x32x16_bf16 v[64:79], v[32:35], v[40:43], v[64:79]
    v_add_u32 v152, 2048, v152
    v_lshlrev_b32 v198, 3, v1
    v_add_u32 v198, 1031, v198
    v_cndmask_b32 v152, v152, v198, s[22:23]
    v_mfma_f32_32x32x16_bf16 v[80:95], v[36:39], v[44:47], v[80:95]
    v_mov_b32 v153, 16
    v_cndmask_b32 v153, v153, 1, s[22:23]
    v_mov_b32 v198, 1040
    v_cndmask_b32 v198, v198, 0, s[22:23]
    v_mfma_f32_32x32x16_bf16 v[64:79], v[36:39], v[40:43], v[64:79]
    v_sub_u32 v154, v152, v198
    v_mov_b32 v155, 1008
    v_mov_b32 v198, 1035
    v_cndmask_b32 v155, v155, v198, s[22:23]
    ds_read2_b32 v[32:33], v5 offset0:64 offset1:65
    ds_read2_b32 v[34:35], v5 offset0:66 offset1:67
    ds_read2_b32 v[36:37], v8 offset0:64 offset1:65
    ds_read2_b32 v[38:39], v8 offset0:66 offset1:67
    ds_read_b128 v[40:43], v10 offset:1600
    ds_read_b128 v[44:47], v10 offset:4160
    s_waitcnt lgkmcnt(14)
    v_mfma_f32_32x32x16_bf16 v[80:95], v[48:51], v[60:63], v[80:95]
    v_lshlrev_b32 v199, 4, v1
    v_lshlrev_b32 v198, 9, v157
    v_lshl_add_u32 v198, v156, 4, v198
    v_add_u32 v198, s26, v198
    v_mfma_f32_32x32x16_bf16 v[64:79], v[48:51], v[56:59], v[64:79]
    s_add_u32 s27, s18, 112
    v_sub_u32 v157, s27, v199
    v_cndmask_b32 v158, v199, v198, s[24:25]
    v_cndmask_b32 v158, v158, v157, s[22:23]
    v_mfma_f32_32x32x16_bf16 v[80:95], v[52:55], v[60:63], v[80:95]
    v_add_u32 v198, 256, v198
    v_cndmask_b32 v159, v199, v198, s[24:25]
    v_add_u32 v198, 4480, v157
    v_cndmask_b32 v159, v159, v198, s[22:23]
    v_mfma_f32_32x32x16_bf16 v[64:79], v[52:55], v[56:59], v[64:79]
    v_add_u32 v198, 2240, v157
    v_cndmask_b32 v160, v199, v198, s[22:23]
    v_add_u32 v198, 6720, v157
    v_cndmask_b32 v161, v199, v198, s[22:23]
    ds_read2_b32 v[48:49], v5 offset0:48 offset1:49
    ds_read2_b32 v[50:51], v5 offset0:50 offset1:51
    ds_read2_b32 v[52:53], v8 offset0:48 offset1:49
    ds_read2_b32 v[54:55], v8 offset0:50 offset1:51
    ds_read_b128 v[56:59], v10 offset:1520
    ds_read_b128 v[60:63], v10 offset:4080
    s_waitcnt lgkmcnt(12)
    v_mfma_f32_32x32x16_bf16 v[80:95], v[16:19], v[28:31], v[80:95]
    s_add_u32 s27, s19, 3072
    v_bfe_u32 v156, v152, 3, 1
    v_add3_u32 v156, v152, 3, v156
    v_lshrrev_b32 v156, 3, v156
    v_mfma_f32_32x32x16_bf16 v[64:79], v[16:19], v[24:27], v[64:79]
    v_lshl_add_u32 v156, v156, 2, s27
    ds_read2st64_b32 v[162:163], v156 offset0:0 offset1:17
    v_sub_u32 v152, v152, v153
    v_bfe_u32 v156, v152, 3, 1
    v_mfma_f32_32x32x16_bf16 v[80:95], v[20:23], v[28:31], v[80:95]
    v_add3_u32 v156, v152, 3, v156
    v_lshrrev_b32 v156, 3, v156
    v_lshl_add_u32 v156, v156, 2, s27
    ds_read2st64_b32 v[164:165], v156 offset0:0 offset1:17
    v_mfma_f32_32x32x16_bf16 v[64:79], v[20:23], v[24:27], v[64:79]
    v_sub_u32 v152, v152, v153
    v_bfe_u32 v156, v152, 3, 1
    v_add3_u32 v156, v152, 3, v156
    v_lshrrev_b32 v156, 3, v156
    ds_read2_b32 v[16:17], v5 offset0:32 offset1:33
    ds_read2_b32 v[18:19], v5 offset0:34 offset1:35
    ds_read2_b32 v[20:21], v8 offset0:32 offset1:33
    ds_read2_b32 v[22:23], v8 offset0:34 offset1:35
    ds_read_b128 v[24:27], v10 offset:1440
    ds_read_b128 v[28:31], v10 offset:4000
    s_waitcnt lgkmcnt(14)
    v_mfma_f32_32x32x16_bf16 v[80:95], v[32:35], v[44:47], v[80:95]
    v_lshl_add_u32 v156, v156, 2, s27
    ds_read2st64_b32 v[166:167], v156 offset0:0 offset1:17
    v_sub_u32 v152, v152, v153
    v_bfe_u32 v156, v152, 3, 1
    v_mfma_f32_32x32x16_bf16 v[64:79], v[32:35], v[40:43], v[64:79]
    v_add3_u32 v156, v152, 3, v156
    v_lshrrev_b32 v156, 3, v156
    v_lshl_add_u32 v156, v156, 2, s27
    ds_read2st64_b32 v[168:169], v156 offset0:0 offset1:17
    v_mfma_f32_32x32x16_bf16 v[80:95], v[36:39], v[44:47], v[80:95]
    v_sub_u32 v152, v152, v153
    v_bfe_u32 v156, v152, 3, 1
    v_add3_u32 v156, v152, 3, v156
    v_lshrrev_b32 v156, 3, v156
    v_mfma_f32_32x32x16_bf16 v[64:79], v[36:39], v[40:43], v[64:79]
    v_lshl_add_u32 v156, v156, 2, s27
    ds_read2st64_b32 v[170:171], v156 offset0:0 offset1:17
    v_sub_u32 v152, v152, v153
    v_bfe_u32 v156, v152, 3, 1
    ds_read2_b32 v[32:33], v5 offset0:16 offset1:17
    ds_read2_b32 v[34:35], v5 offset0:18 offset1:19
    ds_read2_b32 v[36:37], v8 offset0:16 offset1:17
    ds_read2_b32 v[38:39], v8 offset0:18 offset1:19
    ds_read_b128 v[40:43], v10 offset:1360
    ds_read_b128 v[44:47], v10 offset:3920
    s_waitcnt lgkmcnt(15)
    v_mfma_f32_32x32x16_bf16 v[80:95], v[48:51], v[60:63], v[80:95]
    v_add3_u32 v156, v152, 3, v156
    v_lshrrev_b32 v156, 3, v156
    v_lshl_add_u32 v156, v156, 2, s27
    ds_read2st64_b32 v[172:173], v156 offset0:0 offset1:17
    v_mfma_f32_32x32x16_bf16 v[64:79], v[48:51], v[56:59], v[64:79]
    v_sub_u32 v152, v152, v153
    v_bfe_u32 v156, v152, 3, 1
    v_add3_u32 v156, v152, 3, v156
    v_lshrrev_b32 v156, 3, v156
    v_mfma_f32_32x32x16_bf16 v[80:95], v[52:55], v[60:63], v[80:95]
    v_lshl_add_u32 v156, v156, 2, s27
    ds_read2st64_b32 v[174:175], v156 offset0:0 offset1:17
    v_sub_u32 v152, v152, v153
    v_bfe_u32 v156, v152, 3, 1
    v_mfma_f32_32x32x16_bf16 v[64:79], v[52:55], v[56:59], v[64:79]
    v_add3_u32 v156, v152, 3, v156
    v_lshrrev_b32 v156, 3, v156
    v_lshl_add_u32 v156, v156, 2, s27
    ds_read2st64_b32 v[176:177], v156 offset0:0 offset1:17
    ds_read2_b32 v[48:49], v5 offset0:0 offset1:1
    ds_read2_b32 v[50:51], v5 offset0:2 offset1:3
    ds_read2_b32 v[52:53], v8 offset0:0 offset1:1
    ds_read2_b32 v[54:55], v8 offset0:2 offset1:3
    ds_read_b128 v[56:59], v10 offset:1280
    ds_read_b128 v[60:63], v10 offset:3840
    s_waitcnt lgkmcnt(15)
    v_mfma_f32_32x32x16_bf16 v[80:95], v[16:19], v[28:31], v[80:95]
    v_sub_u32 v152, v152, v153
    v_bfe_u32 v156, v152, 3, 1
    v_add3_u32 v156, v152, 3, v156
    v_lshrrev_b32 v156, 3, v156
    v_mfma_f32_32x32x16_bf16 v[64:79], v[16:19], v[24:27], v[64:79]
    v_lshl_add_u32 v156, v156, 2, s27
    ds_read2st64_b32 v[178:179], v156 offset0:0 offset1:17
    v_sub_u32 v152, v152, v153
    s_waitcnt lgkmcnt(15)
    v_mfma_f32_32x32x16_bf16 v[80:95], v[20:23], v[28:31], v[80:95]
    v_add_f32 v162, v162, v163
    v_cmp_ge_u32 vcc, v155, v154
    s_nop 1
    v_cndmask_b32 v162, 0, v162, vcc
    v_sub_u32 v154, v154, v153
    v_mfma_f32_32x32x16_bf16 v[64:79], v[20:23], v[24:27], v[64:79]
    s_waitcnt lgkmcnt(15)
    v_add_f32 v164, v164, v165
    v_cmp_ge_u32 vcc, v155, v154
    s_nop 1
    v_cndmask_b32 v164, 0, v164, vcc
    ds_read2_b32 v[16:17], v4 offset0:240 offset1:241
    ds_read2_b32 v[18:19], v4 offset0:242 offset1:243
    ds_read2_b32 v[20:21], v7 offset0:240 offset1:241
    ds_read2_b32 v[22:23], v7 offset0:242 offset1:243
    ds_read_b128 v[24:27], v10 offset:1200
    ds_read_b128 v[28:31], v10 offset:3760
    s_waitcnt lgkmcnt(15)
    v_mfma_f32_32x32x16_bf16 v[80:95], v[32:35], v[44:47], v[80:95]
    v_sub_u32 v154, v154, v153
    s_waitcnt lgkmcnt(15)
    v_add_f32 v166, v166, v167
    v_cmp_ge_u32 vcc, v155, v154
    v_mfma_f32_32x32x16_bf16 v[64:79], v[32:35], v[40:43], v[64:79]
    s_nop 0
    v_cndmask_b32 v166, 0, v166, vcc
    v_sub_u32 v154, v154, v153
    s_waitcnt lgkmcnt(15)
    v_add_f32 v168, v168, v169
    v_mfma_f32_32x32x16_bf16 v[80:95], v[36:39], v[44:47], v[80:95]
    v_cmp_ge_u32 vcc, v155, v154
    s_nop 1
    v_cndmask_b32 v168, 0, v168, vcc
    v_sub_u32 v154, v154, v153
    s_waitcnt lgkmcnt(15)
    v_mfma_f32_32x32x16_bf16 v[64:79], v[36:39], v[40:43], v[64:79]
    v_add_f32 v170, v170, v171
    v_cmp_ge_u32 vcc, v155, v154
    s_nop 1
    v_cndmask_b32 v170, 0, v170, vcc
    v_sub_u32 v154, v154, v153
    ds_read2_b32 v[32:33], v4 offset0:224 offset1:225
    ds_read2_b32 v[34:35], v4 offset0:226 offset1:227
    ds_read2_b32 v[36:37], v7 offset0:224 offset1:225
    ds_read2_b32 v[38:39], v7 offset0:226 offset1:227
    ds_read_b128 v[40:43], v10 offset:1120
    ds_read_b128 v[44:47], v10 offset:3680
    s_waitcnt lgkmcnt(13)
    v_mfma_f32_32x32x16_bf16 v[80:95], v[48:51], v[60:63], v[80:95]
    s_waitcnt lgkmcnt(15)
    v_add_f32 v172, v172, v173
    v_cmp_ge_u32 vcc, v155, v154
    s_nop 1
    v_cndmask_b32 v172, 0, v172, vcc
    v_mfma_f32_32x32x16_bf16 v[64:79], v[48:51], v[56:59], v[64:79]
    v_sub_u32 v154, v154, v153
    s_waitcnt lgkmcnt(15)
    v_add_f32 v174, v174, v175
    v_cmp_ge_u32 vcc, v155, v154
    v_mfma_f32_32x32x16_bf16 v[80:95], v[52:55], v[60:63], v[80:95]
    s_nop 0
    v_cndmask_b32 v174, 0, v174, vcc
    v_sub_u32 v154, v154, v153
    s_waitcnt lgkmcnt(15)
    v_add_f32 v176, v176, v177
    v_mfma_f32_32x32x16_bf16 v[64:79], v[52:55], v[56:59], v[64:79]
    v_cmp_ge_u32 vcc, v155, v154
    s_nop 1
    v_cndmask_b32 v176, 0, v176, vcc
    v_sub_u32 v154, v154, v153
    s_waitcnt lgkmcnt(12)
    ds_read2_b32 v[48:49], v4 offset0:208 offset1:209
    ds_read2_b32 v[50:51], v4 offset0:210 offset1:211
    ds_read2_b32 v[52:53], v7 offset0:208 offset1:209
    ds_read2_b32 v[54:55], v7 offset0:210 offset1:211
    ds_read_b128 v[56:59], v10 offset:1040
    ds_read_b128 v[60:63], v10 offset:3600
    s_waitcnt lgkmcnt(12)
    v_mfma_f32_32x32x16_bf16 v[80:95], v[16:19], v[28:31], v[80:95]
    v_add_f32 v178, v178, v179
    v_cmp_ge_u32 vcc, v155, v154
    s_nop 1
    v_cndmask_b32 v178, 0, v178, vcc
    v_sub_u32 v154, v154, v153
    v_mfma_f32_32x32x16_bf16 v[64:79], v[16:19], v[24:27], v[64:79]
    v_cvt_pk_bf16_f32 v180, v162, v164
    v_cvt_pk_bf16_f32 v181, v166, v168
    v_cvt_pk_bf16_f32 v182, v170, v172
    v_cvt_pk_bf16_f32 v183, v174, v176
    v_mfma_f32_32x32x16_bf16 v[80:95], v[20:23], v[28:31], v[80:95]
    v_cvt_pk_bf16_f32 v184, v178, v178
    v_lshlrev_b32 v156, 16, v180
    v_and_b32 v157, 0xffff0000, v180
    v_sub_f32 v156, v162, v156
    v_mfma_f32_32x32x16_bf16 v[64:79], v[20:23], v[24:27], v[64:79]
    v_sub_f32 v157, v164, v157
    v_cvt_pk_bf16_f32 v186, v156, v157
    v_lshlrev_b32 v156, 16, v181
    v_and_b32 v157, 0xffff0000, v181
    ds_read2_b32 v[16:17], v4 offset0:192 offset1:193
    ds_read2_b32 v[18:19], v4 offset0:194 offset1:195
    ds_read2_b32 v[20:21], v7 offset0:192 offset1:193
    ds_read2_b32 v[22:23], v7 offset0:194 offset1:195
    ds_read_b128 v[24:27], v10 offset:960
    ds_read_b128 v[28:31], v10 offset:3520
    s_waitcnt lgkmcnt(12)
    v_mfma_f32_32x32x16_bf16 v[80:95], v[32:35], v[44:47], v[80:95]
    v_sub_f32 v156, v166, v156
    v_sub_f32 v157, v168, v157
    v_cvt_pk_bf16_f32 v187, v156, v157
    v_lshlrev_b32 v156, 16, v182
    v_mfma_f32_32x32x16_bf16 v[64:79], v[32:35], v[40:43], v[64:79]
    v_and_b32 v157, 0xffff0000, v182
    v_sub_f32 v156, v170, v156
    v_sub_f32 v157, v172, v157
    v_cvt_pk_bf16_f32 v188, v156, v157
    v_mfma_f32_32x32x16_bf16 v[80:95], v[36:39], v[44:47], v[80:95]
    v_lshlrev_b32 v156, 16, v183
    v_and_b32 v157, 0xffff0000, v183
    v_sub_f32 v156, v174, v156
    v_sub_f32 v157, v176, v157
    v_mfma_f32_32x32x16_bf16 v[64:79], v[36:39], v[40:43], v[64:79]
    v_cvt_pk_bf16_f32 v189, v156, v157
    v_lshlrev_b32 v156, 16, v184
    v_sub_f32 v156, v178, v156
    v_cvt_pk_bf16_f32 v190, v156, v156
    ds_read2_b32 v[32:33], v4 offset0:176 offset1:177
    ds_read2_b32 v[34:35], v4 offset0:178 offset1:179
    ds_read2_b32 v[36:37], v7 offset0:176 offset1:177
    ds_read2_b32 v[38:39], v7 offset0:178 offset1:179
    ds_read_b128 v[40:43], v10 offset:880
    ds_read_b128 v[44:47], v10 offset:3440
    s_waitcnt lgkmcnt(12)
    v_mfma_f32_32x32x16_bf16 v[80:95], v[48:51], v[60:63], v[80:95]
    v_alignbit_b32 v192, v181, v180, 16
    v_alignbit_b32 v193, v182, v181, 16
    v_alignbit_b32 v194, v183, v182, 16
    v_alignbit_b32 v195, v184, v183, 16
    v_mfma_f32_32x32x16_bf16 v[64:79], v[48:51], v[56:59], v[64:79]
    v_alignbit_b32 v196, v187, v186, 16
    v_alignbit_b32 v197, v188, v187, 16
    v_alignbit_b32 v198, v189, v188, 16
    v_alignbit_b32 v199, v190, v189, 16
    v_mfma_f32_32x32x16_bf16 v[80:95], v[52:55], v[60:63], v[80:95]
    ds_write_b128 v158, v[180:183]
    ds_write_b128 v159, v[186:189]
    ds_write_b128 v160, v[192:195]
    ds_write_b128 v161, v[196:199]
    v_mfma_f32_32x32x16_bf16 v[64:79], v[52:55], v[56:59], v[64:79]
    s_waitcnt vmcnt(0)
    buffer_store_dwordx4 v[96:99], v105, s[52:55], s28 offen sc0 sc1
    buffer_store_dwordx4 v[100:103], v105, s[52:55], s29 offen sc0 sc1
    ds_read2_b32 v[48:49], v4 offset0:160 offset1:161
    ds_read2_b32 v[50:51], v4 offset0:162 offset1:163
    ds_read2_b32 v[52:53], v7 offset0:160 offset1:161
    ds_read2_b32 v[54:55], v7 offset0:162 offset1:163
    ds_read_b128 v[56:59], v10 offset:800
    ds_read_b128 v[60:63], v10 offset:3360
    s_waitcnt lgkmcnt(15)
    v_mfma_f32_32x32x16_bf16 v[80:95], v[16:19], v[28:31], v[80:95]
    v_mfma_f32_32x32x16_bf16 v[64:79], v[16:19], v[24:27], v[64:79]
    v_mfma_f32_32x32x16_bf16 v[80:95], v[20:23], v[28:31], v[80:95]
    v_mfma_f32_32x32x16_bf16 v[64:79], v[20:23], v[24:27], v[64:79]
    ds_read2_b32 v[16:17], v4 offset0:144 offset1:145
    ds_read2_b32 v[18:19], v4 offset0:146 offset1:147
    ds_read2_b32 v[20:21], v7 offset0:144 offset1:145
    ds_read2_b32 v[22:23], v7 offset0:146 offset1:147
    ds_read_b128 v[24:27], v10 offset:720
    ds_read_b128 v[28:31], v10 offset:3280
    s_waitcnt lgkmcnt(15)
    v_mfma_f32_32x32x16_bf16 v[80:95], v[32:35], v[44:47], v[80:95]
    v_mfma_f32_32x32x16_bf16 v[64:79], v[32:35], v[40:43], v[64:79]
    v_mfma_f32_32x32x16_bf16 v[80:95], v[36:39], v[44:47], v[80:95]
    v_mfma_f32_32x32x16_bf16 v[64:79], v[36:39], v[40:43], v[64:79]
    ds_read2_b32 v[32:33], v4 offset0:128 offset1:129
    ds_read2_b32 v[34:35], v4 offset0:130 offset1:131
    ds_read2_b32 v[36:37], v7 offset0:128 offset1:129
    ds_read2_b32 v[38:39], v7 offset0:130 offset1:131
    ds_read_b128 v[40:43], v10 offset:640
    ds_read_b128 v[44:47], v10 offset:3200
    s_waitcnt lgkmcnt(12)
    v_mfma_f32_32x32x16_bf16 v[80:95], v[48:51], v[60:63], v[80:95]
    v_mfma_f32_32x32x16_bf16 v[64:79], v[48:51], v[56:59], v[64:79]
    v_mfma_f32_32x32x16_bf16 v[80:95], v[52:55], v[60:63], v[80:95]
    v_mfma_f32_32x32x16_bf16 v[64:79], v[52:55], v[56:59], v[64:79]
    ds_read2_b32 v[48:49], v4 offset0:112 offset1:113
    ds_read2_b32 v[50:51], v4 offset0:114 offset1:115
    ds_read2_b32 v[52:53], v7 offset0:112 offset1:113
    ds_read2_b32 v[54:55], v7 offset0:114 offset1:115
    ds_read_b128 v[56:59], v10 offset:560
    ds_read_b128 v[60:63], v10 offset:3120
    s_waitcnt lgkmcnt(12)
    v_mfma_f32_32x32x16_bf16 v[80:95], v[16:19], v[28:31], v[80:95]
    v_mfma_f32_32x32x16_bf16 v[64:79], v[16:19], v[24:27], v[64:79]
    v_mfma_f32_32x32x16_bf16 v[80:95], v[20:23], v[28:31], v[80:95]
    v_mfma_f32_32x32x16_bf16 v[64:79], v[20:23], v[24:27], v[64:79]
    ds_read2_b32 v[16:17], v4 offset0:96 offset1:97
    ds_read2_b32 v[18:19], v4 offset0:98 offset1:99
    ds_read2_b32 v[20:21], v7 offset0:96 offset1:97
    ds_read2_b32 v[22:23], v7 offset0:98 offset1:99
    ds_read_b128 v[24:27], v10 offset:480
    ds_read_b128 v[28:31], v10 offset:3040
    s_waitcnt lgkmcnt(12)
    v_mfma_f32_32x32x16_bf16 v[80:95], v[32:35], v[44:47], v[80:95]
    v_mfma_f32_32x32x16_bf16 v[64:79], v[32:35], v[40:43], v[64:79]
    v_mfma_f32_32x32x16_bf16 v[80:95], v[36:39], v[44:47], v[80:95]
    v_mfma_f32_32x32x16_bf16 v[64:79], v[36:39], v[40:43], v[64:79]
    ds_read2_b32 v[32:33], v4 offset0:80 offset1:81
    ds_read2_b32 v[34:35], v4 offset0:82 offset1:83
    ds_read2_b32 v[36:37], v7 offset0:80 offset1:81
    ds_read2_b32 v[38:39], v7 offset0:82 offset1:83
    ds_read_b128 v[40:43], v10 offset:400
    ds_read_b128 v[44:47], v10 offset:2960
    s_waitcnt lgkmcnt(12)
    v_mfma_f32_32x32x16_bf16 v[80:95], v[48:51], v[60:63], v[80:95]
    v_mfma_f32_32x32x16_bf16 v[64:79], v[48:51], v[56:59], v[64:79]
    v_mfma_f32_32x32x16_bf16 v[80:95], v[52:55], v[60:63], v[80:95]
    v_mfma_f32_32x32x16_bf16 v[64:79], v[52:55], v[56:59], v[64:79]
    ds_read2_b32 v[48:49], v4 offset0:64 offset1:65
    ds_read2_b32 v[50:51], v4 offset0:66 offset1:67
    ds_read2_b32 v[52:53], v7 offset0:64 offset1:65
    ds_read2_b32 v[54:55], v7 offset0:66 offset1:67
    ds_read_b128 v[56:59], v10 offset:320
    ds_read_b128 v[60:63], v10 offset:2880
    s_waitcnt lgkmcnt(12)
    v_mfma_f32_32x32x16_bf16 v[80:95], v[16:19], v[28:31], v[80:95]
    v_mfma_f32_32x32x16_bf16 v[64:79], v[16:19], v[24:27], v[64:79]
    v_mfma_f32_32x32x16_bf16 v[80:95], v[20:23], v[28:31], v[80:95]
    v_mfma_f32_32x32x16_bf16 v[64:79], v[20:23], v[24:27], v[64:79]
    ds_read2_b32 v[16:17], v4 offset0:48 offset1:49
    ds_read2_b32 v[18:19], v4 offset0:50 offset1:51
    ds_read2_b32 v[20:21], v7 offset0:48 offset1:49
    ds_read2_b32 v[22:23], v7 offset0:50 offset1:51
    ds_read_b128 v[24:27], v10 offset:240
    ds_read_b128 v[28:31], v10 offset:2800
    s_waitcnt lgkmcnt(12)
    v_mfma_f32_32x32x16_bf16 v[80:95], v[32:35], v[44:47], v[80:95]
    v_mfma_f32_32x32x16_bf16 v[64:79], v[32:35], v[40:43], v[64:79]
    v_mfma_f32_32x32x16_bf16 v[80:95], v[36:39], v[44:47], v[80:95]
    v_mfma_f32_32x32x16_bf16 v[64:79], v[36:39], v[40:43], v[64:79]
    s_waitcnt lgkmcnt(0)
    s_barrier
    ds_read2_b32 v[32:33], v4 offset0:32 offset1:33
    ds_read2_b32 v[34:35], v4 offset0:34 offset1:35
    ds_read2_b32 v[36:37], v7 offset0:32 offset1:33
    ds_read2_b32 v[38:39], v7 offset0:34 offset1:35
    ds_read_b128 v[40:43], v10 offset:160
    ds_read_b128 v[44:47], v10 offset:2720
    s_waitcnt lgkmcnt(12)
    v_mfma_f32_32x32x16_bf16 v[80:95], v[48:51], v[60:63], v[80:95]
    v_mfma_f32_32x32x16_bf16 v[64:79], v[48:51], v[56:59], v[64:79]
    v_mfma_f32_32x32x16_bf16 v[80:95], v[52:55], v[60:63], v[80:95]
    v_mfma_f32_32x32x16_bf16 v[64:79], v[52:55], v[56:59], v[64:79]
    ds_read2_b32 v[48:49], v4 offset0:16 offset1:17
    ds_read2_b32 v[50:51], v4 offset0:18 offset1:19
    ds_read2_b32 v[52:53], v7 offset0:16 offset1:17
    ds_read2_b32 v[54:55], v7 offset0:18 offset1:19
    ds_read_b128 v[60:63], v10 offset:2640
    s_waitcnt lgkmcnt(11)
    v_mfma_f32_32x32x16_bf16 v[80:95], v[16:19], v[28:31], v[80:95]
    v_mfma_f32_32x32x16_bf16 v[64:79], v[16:19], v[24:27], v[64:79]
    v_mfma_f32_32x32x16_bf16 v[80:95], v[20:23], v[28:31], v[80:95]
    v_mfma_f32_32x32x16_bf16 v[64:79], v[20:23], v[24:27], v[64:79]
    ds_read2_b32 v[16:17], v4 offset0:0 offset1:1
    ds_read2_b32 v[18:19], v4 offset0:2 offset1:3
    ds_read2_b32 v[20:21], v7 offset0:0 offset1:1
    ds_read2_b32 v[22:23], v7 offset0:2 offset1:3
    ds_read_b128 v[28:31], v10 offset:2560
    s_waitcnt lgkmcnt(10)
    v_mfma_f32_32x32x16_bf16 v[80:95], v[32:35], v[44:47], v[80:95]
    v_mfma_f32_32x32x16_bf16 v[64:79], v[32:35], v[40:43], v[64:79]
    v_mfma_f32_32x32x16_bf16 v[80:95], v[36:39], v[44:47], v[80:95]
    v_mfma_f32_32x32x16_bf16 v[64:79], v[36:39], v[40:43], v[64:79]
    ds_read_b64_tr_b16 v[32:33], v11 offset:0
    ds_read_b64_tr_b16 v[34:35], v11 offset:128
    ds_read_b64_tr_b16 v[36:37], v11 offset:2080
    ds_read_b64_tr_b16 v[38:39], v11 offset:2208
    ds_read2_b32 v[40:41], v12 offset0:0 offset1:1
    ds_read2_b32 v[42:43], v12 offset0:2 offset1:3
    ds_read2_b32 v[44:45], v12 offset0:64 offset1:65
    ds_read2_b32 v[46:47], v12 offset0:66 offset1:67
    s_waitcnt lgkmcnt(13)
    v_mfma_f32_32x32x16_bf16 v[80:95], v[48:51], v[60:63], v[80:95]
    v_mfma_f32_32x32x16_bf16 v[80:95], v[52:55], v[60:63], v[80:95]
    ds_read_b64_tr_b16 v[48:49], v11 offset:512
    ds_read_b64_tr_b16 v[50:51], v11 offset:640
    ds_read_b64_tr_b16 v[52:53], v11 offset:2592
    ds_read_b64_tr_b16 v[54:55], v11 offset:2720
    ds_read2_b32 v[56:57], v12 offset0:8 offset1:9
    ds_read2_b32 v[58:59], v12 offset0:10 offset1:11
    ds_read2_b32 v[60:61], v12 offset0:72 offset1:73
    ds_read2_b32 v[62:63], v12 offset0:74 offset1:75
    s_waitcnt lgkmcnt(15)
    v_mfma_f32_32x32x16_bf16 v[80:95], v[16:19], v[28:31], v[80:95]
    v_mfma_f32_32x32x16_bf16 v[80:95], v[20:23], v[28:31], v[80:95]
    ds_read_b64_tr_b16 v[16:17], v11 offset:1024
    ds_read_b64_tr_b16 v[18:19], v11 offset:1152
    ds_read_b64_tr_b16 v[20:21], v11 offset:3104
    ds_read_b64_tr_b16 v[22:23], v11 offset:3232
    ds_read2_b32 v[24:25], v12 offset0:16 offset1:17
    ds_read2_b32 v[26:27], v12 offset0:18 offset1:19
    ds_read2_b32 v[28:29], v12 offset0:80 offset1:81
    ds_read2_b32 v[30:31], v12 offset0:82 offset1:83
    s_waitcnt lgkmcnt(15)
    v_mfma_f32_32x32x16_bf16 v[80:95], v[32:35], v[40:43], v[80:95]
    v_mfma_f32_32x32x16_bf16 v[80:95], v[36:39], v[40:43], v[80:95]
    v_mfma_f32_32x32x16_bf16 v[80:95], v[32:35], v[44:47], v[80:95]
    ds_read_b64_tr_b16 v[32:33], v11 offset:1536
    ds_read_b64_tr_b16 v[34:35], v11 offset:1664
    ds_read_b64_tr_b16 v[36:37], v11 offset:3616
    ds_read_b64_tr_b16 v[38:39], v11 offset:3744
    ds_read2_b32 v[40:41], v12 offset0:24 offset1:25
    ds_read2_b32 v[42:43], v12 offset0:26 offset1:27
    ds_read2_b32 v[44:45], v12 offset0:88 offset1:89
    ds_read2_b32 v[46:47], v12 offset0:90 offset1:91
    s_waitcnt lgkmcnt(15)
    v_mfma_f32_32x32x16_bf16 v[80:95], v[48:51], v[56:59], v[80:95]
    v_mfma_f32_32x32x16_bf16 v[80:95], v[52:55], v[56:59], v[80:95]
    v_mfma_f32_32x32x16_bf16 v[80:95], v[48:51], v[60:63], v[80:95]
    s_waitcnt lgkmcnt(8)
    v_mfma_f32_32x32x16_bf16 v[80:95], v[16:19], v[24:27], v[80:95]
    v_mfma_f32_32x32x16_bf16 v[80:95], v[20:23], v[24:27], v[80:95]
    v_mfma_f32_32x32x16_bf16 v[80:95], v[16:19], v[28:31], v[80:95]
    s_waitcnt lgkmcnt(0)
    v_mfma_f32_32x32x16_bf16 v[80:95], v[32:35], v[40:43], v[80:95]
    v_mfma_f32_32x32x16_bf16 v[80:95], v[36:39], v[40:43], v[80:95]
    v_mfma_f32_32x32x16_bf16 v[80:95], v[32:35], v[44:47], v[80:95]
    s_barrier
    s_lshl_b32 s17, s7, 12
    v_lshlrev_b32 v9, 4, v1
    v_add_u32 v4, s17, v9
    s_xor_b32 s19, s17, 0x1000
    v_add_u32 v5, s19, v9
    s_cmp_eq_u32 s16, 0
    s_nop 4
    s_cbranch_scc0 L_ssm_h1w
    ds_write_b128 v4, v[80:83] offset:37184
    ds_write_b128 v4, v[84:87] offset:38208
    ds_write_b128 v4, v[88:91] offset:39232
    ds_write_b128 v4, v[92:95] offset:40256
    s_branch L_ssm_wdone
L_ssm_h1w:
    ds_write_b128 v4, v[64:67] offset:37184
    ds_write_b128 v4, v[68:71] offset:38208
    ds_write_b128 v4, v[72:75] offset:39232
    ds_write_b128 v4, v[76:79] offset:40256
    v_mov_b32 v64, v80
    v_mov_b32 v65, v81
    v_mov_b32 v66, v82
    v_mov_b32 v67, v83
    v_mov_b32 v68, v84
    v_mov_b32 v69, v85
    v_mov_b32 v70, v86
    v_mov_b32 v71, v87
    v_mov_b32 v72, v88
    v_mov_b32 v73, v89
    v_mov_b32 v74, v90
    v_mov_b32 v75, v91
    v_mov_b32 v76, v92
    v_mov_b32 v77, v93
    v_mov_b32 v78, v94
    v_mov_b32 v79, v95
L_ssm_wdone:
    s_waitcnt lgkmcnt(0)
    s_barrier
    ds_read_b128 v[16:19], v5 offset:37184
    ds_read_b128 v[20:23], v5 offset:38208
    ds_read_b128 v[24:27], v5 offset:39232
    ds_read_b128 v[28:31], v5 offset:40256
    v_lshlrev_b32 v6, 6, v2
    v_lshl_add_u32 v6, v3, 3, v6
    v_lshl_add_u32 v7, v2, 4, v6
    s_lshl_b32 s19, s16, 11
    s_mul_i32 s17, s16, 2560
    s_add_u32 s17, s17, s20
    v_add_u32 v7, s17, v7
    ds_read_b64 v[32:33], v7 offset:2720
    ds_read_b64 v[34:35], v7 offset:2736
    ds_read_b64 v[36:37], v7 offset:2752
    ds_read_b64 v[38:39], v7 offset:2768
    s_add_u32 s17, s3, s15
    s_lshl_b32 s17, s17, 6
    s_lshl_b32 s19, s16, 20
    s_add_u32 s17, s17, s19
    s_add_u32 s17, s17, 6291456
    v_lshlrev_b32 v8, 15, v2
    v_lshl_add_u32 v8, v3, 5, v8
    v_add_u32 v8, s17, v8
    s_waitcnt lgkmcnt(0)
    v_add_f32 v64, v64, v16
    v_add_f32 v65, v65, v17
    v_add_f32 v66, v66, v18
    v_add_f32 v67, v67, v19
    v_add_f32 v68, v68, v20
    v_add_f32 v69, v69, v21
    v_add_f32 v70, v70, v22
    v_add_f32 v71, v71, v23
    v_add_f32 v72, v72, v24
    v_add_f32 v73, v73, v25
    v_add_f32 v74, v74, v26
    v_add_f32 v75, v75, v27
    v_add_f32 v76, v76, v28
    v_add_f32 v77, v77, v29
    v_add_f32 v78, v78, v30
    v_add_f32 v79, v79, v31
    v_cvt_pk_bf16_f32 v42, 0, v64
    v_cvt_pk_bf16_f32 v43, 0, v65
    v_cvt_pk_bf16_f32 v44, 0, v66
    v_cvt_pk_bf16_f32 v45, 0, v67
    v_lshlrev_b32 v46, 16, v32
    v_and_b32 v47, 0xffff0000, v32
    v_lshlrev_b32 v48, 16, v33
    v_and_b32 v49, 0xffff0000, v33
    v_mul_f32 v46, s13, v46
    v_mul_f32 v47, s13, v47
    v_mul_f32 v48, s13, v48
    v_mul_f32 v49, s13, v49
    v_cvt_pk_bf16_f32 v46, 0, v46
    v_cvt_pk_bf16_f32 v47, 0, v47
    v_cvt_pk_bf16_f32 v48, 0, v48
    v_cvt_pk_bf16_f32 v49, 0, v49
    v_add_f32 v42, v42, v46
    v_add_f32 v43, v43, v47
    v_add_f32 v44, v44, v48
    v_add_f32 v45, v45, v49
    v_cvt_pk_bf16_f32 v52, v42, v43
    v_cvt_pk_bf16_f32 v53, v44, v45
    v_cvt_pk_bf16_f32 v42, 0, v68
    v_cvt_pk_bf16_f32 v43, 0, v69
    v_cvt_pk_bf16_f32 v44, 0, v70
    v_cvt_pk_bf16_f32 v45, 0, v71
    v_lshlrev_b32 v46, 16, v34
    v_and_b32 v47, 0xffff0000, v34
    v_lshlrev_b32 v48, 16, v35
    v_and_b32 v49, 0xffff0000, v35
    v_mul_f32 v46, s13, v46
    v_mul_f32 v47, s13, v47
    v_mul_f32 v48, s13, v48
    v_mul_f32 v49, s13, v49
    v_cvt_pk_bf16_f32 v46, 0, v46
    v_cvt_pk_bf16_f32 v47, 0, v47
    v_cvt_pk_bf16_f32 v48, 0, v48
    v_cvt_pk_bf16_f32 v49, 0, v49
    v_add_f32 v42, v42, v46
    v_add_f32 v43, v43, v47
    v_add_f32 v44, v44, v48
    v_add_f32 v45, v45, v49
    v_cvt_pk_bf16_f32 v54, v42, v43
    v_cvt_pk_bf16_f32 v55, v44, v45
    buffer_store_dwordx4 v[52:55], v8, s[52:55], 0 offen offset:0
    v_cvt_pk_bf16_f32 v42, 0, v72
    v_cvt_pk_bf16_f32 v43, 0, v73
    v_cvt_pk_bf16_f32 v44, 0, v74
    v_cvt_pk_bf16_f32 v45, 0, v75
    v_lshlrev_b32 v46, 16, v36
    v_and_b32 v47, 0xffff0000, v36
    v_lshlrev_b32 v48, 16, v37
    v_and_b32 v49, 0xffff0000, v37
    v_mul_f32 v46, s13, v46
    v_mul_f32 v47, s13, v47
    v_mul_f32 v48, s13, v48
    v_mul_f32 v49, s13, v49
    v_cvt_pk_bf16_f32 v46, 0, v46
    v_cvt_pk_bf16_f32 v47, 0, v47
    v_cvt_pk_bf16_f32 v48, 0, v48
    v_cvt_pk_bf16_f32 v49, 0, v49
    v_add_f32 v42, v42, v46
    v_add_f32 v43, v43, v47
    v_add_f32 v44, v44, v48
    v_add_f32 v45, v45, v49
    v_cvt_pk_bf16_f32 v56, v42, v43
    v_cvt_pk_bf16_f32 v57, v44, v45
    v_cvt_pk_bf16_f32 v42, 0, v76
    v_cvt_pk_bf16_f32 v43, 0, v77
    v_cvt_pk_bf16_f32 v44, 0, v78
    v_cvt_pk_bf16_f32 v45, 0, v79
    v_lshlrev_b32 v46, 16, v38
    v_and_b32 v47, 0xffff0000, v38
    v_lshlrev_b32 v48, 16, v39
    v_and_b32 v49, 0xffff0000, v39
    v_mul_f32 v46, s13, v46
    v_mul_f32 v47, s13, v47
    v_mul_f32 v48, s13, v48
    v_mul_f32 v49, s13, v49
    v_cvt_pk_bf16_f32 v46, 0, v46
    v_cvt_pk_bf16_f32 v47, 0, v47
    v_cvt_pk_bf16_f32 v48, 0, v48
    v_cvt_pk_bf16_f32 v49, 0, v49
    v_add_f32 v42, v42, v46
    v_add_f32 v43, v43, v47
    v_add_f32 v44, v44, v48
    v_add_f32 v45, v45, v49
    v_cvt_pk_bf16_f32 v58, v42, v43
    v_cvt_pk_bf16_f32 v59, v44, v45
    buffer_store_dwordx4 v[56:59], v8, s[52:55], 0 offen offset:16
    s_nop 1
    s_endpgm
L_gemm1:
    s_setprio 2
    s_sub_u32 s3, s2, 256
    s_and_b32 s4, s3, 15
    s_lshr_b32 s5, s3, 4
    v_and_b32 v1, 63, v0
    v_lshrrev_b32 v2, 6, v0
    s_nop 0
    v_readfirstlane_b32 s7, v2
    v_and_b32 v2, 31, v1
    v_lshrrev_b32 v3, 5, v1
    v_lshrrev_b32 v8, 2, v1
    v_and_b32 v9, 3, v1
    v_bfe_u32 v10, v1, 4, 2
    v_xor_b32 v9, v9, v10
    s_lshl_b32 s8, s4, 7
    s_lshl_b32 s9, s7, 5
    s_add_u32 s8, s8, s9
    v_add_u32 v8, s8, v8
    v_lshlrev_b32 v8, 10, v8
    v_lshl_add_u32 v8, v9, 4, v8
    v_add_u32 v9, 0x4000, v8
    v_lshrrev_b32 v10, 4, v1
    v_bfe_u32 v11, v1, 2, 2
    v_and_b32 v12, 3, v1
    s_and_b32 s8, s7, 1
    s_mul_i32 s8, s8, 12
    s_mul_i32 s9, s5, 192
    v_add_u32 v13, 0, v10
    v_add_u32 v13, s8, v13
    v_mul_u32_u24 v14, 11, v13
    v_lshrrev_b32 v14, 5, v14
    v_mul_u32_u24 v15, 3, v14
    v_sub_u32 v15, v13, v15
    v_lshl_add_u32 v14, v14, 2, v11
    v_mul_u32_u24 v14, 2752, v14
    v_lshl_add_u32 v14, v15, 6, v14
    v_lshl_add_u32 v14, v12, 4, v14
    v_add_u32 v5, s9, v14
    v_add_u32 v13, 4, v10
    v_add_u32 v13, s8, v13
    v_mul_u32_u24 v14, 11, v13
    v_lshrrev_b32 v14, 5, v14
    v_mul_u32_u24 v15, 3, v14
    v_sub_u32 v15, v13, v15
    v_lshl_add_u32 v14, v14, 2, v11
    v_mul_u32_u24 v14, 2752, v14
    v_lshl_add_u32 v14, v15, 6, v14
    v_lshl_add_u32 v14, v12, 4, v14
    v_add_u32 v6, s9, v14
    v_add_u32 v13, 8, v10
    v_add_u32 v13, s8, v13
    v_mul_u32_u24 v14, 11, v13
    v_lshrrev_b32 v14, 5, v14
    v_mul_u32_u24 v15, 3, v14
    v_sub_u32 v15, v13, v15
    v_lshl_add_u32 v14, v14, 2, v11
    v_mul_u32_u24 v14, 2752, v14
    v_lshl_add_u32 v14, v15, 6, v14
    v_lshl_add_u32 v14, v12, 4, v14
    v_add_u32 v7, s9, v14
    s_mul_i32 s14, s7, 3072
    s_lshl_b32 s15, s7, 11
    s_add_u32 s15, s15, 12288
    v_mul_u32_u24 v13, 1536, v3
    v_lshl_add_u32 v13, v11, 6, v13
    v_and_b32 v14, 1, v10
    v_lshl_add_u32 v13, v14, 5, v13
    v_lshl_add_u32 v13, v12, 3, v13
    v_add_u32 v14, 40960, v13
    v_bfe_u32 v15, v2, 2, 2
    v_xor_b32 v15, v15, v3
    v_lshlrev_b32 v16, 6, v2
    v_add_u32 v16, s15, v16
    v_lshl_add_u32 v17, v15, 4, v16
    v_xor_b32 v15, 2, v15
    v_lshl_add_u32 v18, v15, 4, v16
    v_add_u32 v19, 40960, v17
    v_add_u32 v20, 40960, v18
    s_waitcnt lgkmcnt(0)
    s_mov_b32 s48, s16
    s_and_b32 s49, s17, 0xffff
    s_mov_b32 s50, 2097152
    s_mov_b32 s51, 0x00020000
    s_mov_b32 s52, s44
    s_and_b32 s53, s45, 0xffff
    s_mov_b32 s54, 268435456
    s_mov_b32 s55, 0x00020000
    s_cmp_ge_u32 s7, 2
    s_cselect_b32 s32, s34, s32
    s_cselect_b32 s33, s35, s33
    s_mov_b32 s56, s32
    s_and_b32 s57, s33, 0xffff
    s_mov_b32 s58, 1409024
    s_mov_b32 s59, 0x00020000
    s_mov_b32 s8, 0
    s_add_u32 m0, s14, 0
    s_nop 0
    buffer_load_dwordx4 v5, s[56:59], s8 offen lds
    s_mov_b32 s8, 0
    s_add_u32 m0, s14, 1024
    s_nop 0
    buffer_load_dwordx4 v6, s[56:59], s8 offen lds
    s_mov_b32 s8, 0
    s_add_u32 m0, s14, 2048
    s_nop 0
    buffer_load_dwordx4 v7, s[56:59], s8 offen lds
    s_mov_b32 s8, 0
    s_add_u32 m0, s15, 0
    s_nop 0
    buffer_load_dwordx4 v8, s[48:51], s8 offen lds
    s_mov_b32 s8, 0
    s_add_u32 m0, s15, 1024
    s_nop 0
    buffer_load_dwordx4 v9, s[48:51], s8 offen lds
    s_mov_b32 s8, 88064
    s_add_u32 m0, s14, 20480
    s_nop 0
    buffer_load_dwordx4 v5, s[56:59], s8 offen lds
    s_mov_b32 s8, 88064
    s_add_u32 m0, s14, 21504
    s_nop 0
    buffer_load_dwordx4 v6, s[56:59], s8 offen lds
    s_mov_b32 s8, 88064
    s_add_u32 m0, s14, 22528
    s_nop 0
    buffer_load_dwordx4 v7, s[56:59], s8 offen lds
    s_mov_b32 s8, 64
    s_add_u32 m0, s15, 20480
    s_nop 0
    buffer_load_dwordx4 v8, s[48:51], s8 offen lds
    s_mov_b32 s8, 64
    s_add_u32 m0, s15, 21504
    s_nop 0
    buffer_load_dwordx4 v9, s[48:51], s8 offen lds
    s_mov_b32 s8, 176128
    s_add_u32 m0, s14, 40960
    s_nop 0
    buffer_load_dwordx4 v5, s[56:59], s8 offen lds
    s_mov_b32 s8, 176128
    s_add_u32 m0, s14, 41984
    s_nop 0
    buffer_load_dwordx4 v6, s[56:59], s8 offen lds
    s_mov_b32 s8, 176128
    s_add_u32 m0, s14, 43008
    s_nop 0
    buffer_load_dwordx4 v7, s[56:59], s8 offen lds
    s_mov_b32 s8, 128
    s_add_u32 m0, s15, 40960
    s_nop 0
    buffer_load_dwordx4 v8, s[48:51], s8 offen lds
    s_mov_b32 s8, 128
    s_add_u32 m0, s15, 41984
    s_nop 0
    buffer_load_dwordx4 v9, s[48:51], s8 offen lds
    v_mov_b32 v88, 0
    v_mov_b32 v89, 0
    v_mov_b32 v90, 0
    v_mov_b32 v91, 0
    v_mov_b32 v92, 0
    v_mov_b32 v93, 0
    v_mov_b32 v94, 0
    v_mov_b32 v95, 0
    v_mov_b32 v96, 0
    v_mov_b32 v97, 0
    v_mov_b32 v98, 0
    v_mov_b32 v99, 0
    v_mov_b32 v100, 0
    v_mov_b32 v101, 0
    v_mov_b32 v102, 0
    v_mov_b32 v103, 0
    v_mov_b32 v104, 0
    v_mov_b32 v105, 0
    v_mov_b32 v106, 0
    v_mov_b32 v107, 0
    v_mov_b32 v108, 0
    v_mov_b32 v109, 0
    v_mov_b32 v110, 0
    v_mov_b32 v111, 0
    v_mov_b32 v112, 0
    v_mov_b32 v113, 0
    v_mov_b32 v114, 0
    v_mov_b32 v115, 0
    v_mov_b32 v116, 0
    v_mov_b32 v117, 0
    v_mov_b32 v118, 0
    v_mov_b32 v119, 0
    v_mov_b32 v120, 0
    v_mov_b32 v121, 0
    v_mov_b32 v122, 0
    v_mov_b32 v123, 0
    v_mov_b32 v124, 0
    v_mov_b32 v125, 0
    v_mov_b32 v126, 0
    v_mov_b32 v127, 0
    v_mov_b32 v128, 0
    v_mov_b32 v129, 0
    v_mov_b32 v130, 0
    v_mov_b32 v131, 0
    v_mov_b32 v132, 0
    v_mov_b32 v133, 0
    v_mov_b32 v134, 0
    v_mov_b32 v135, 0
    v_mov_b32 v136, 0
    v_mov_b32 v137, 0
    v_mov_b32 v138, 0
    v_mov_b32 v139, 0
    v_mov_b32 v140, 0
    v_mov_b32 v141, 0
    v_mov_b32 v142, 0
    v_mov_b32 v143, 0
    v_mov_b32 v144, 0
    v_mov_b32 v145, 0
    v_mov_b32 v146, 0
    v_mov_b32 v147, 0
    v_mov_b32 v148, 0
    v_mov_b32 v149, 0
    v_mov_b32 v150, 0
    v_mov_b32 v151, 0
    v_mov_b32 v152, 0
    v_mov_b32 v153, 0
    v_mov_b32 v154, 0
    v_mov_b32 v155, 0
    v_mov_b32 v156, 0
    v_mov_b32 v157, 0
    v_mov_b32 v158, 0
    v_mov_b32 v159, 0
    v_mov_b32 v160, 0
    v_mov_b32 v161, 0
    v_mov_b32 v162, 0
    v_mov_b32 v163, 0
    v_mov_b32 v164, 0
    v_mov_b32 v165, 0
    v_mov_b32 v166, 0
    v_mov_b32 v167, 0
    v_mov_b32 v168, 0
    v_mov_b32 v169, 0
    v_mov_b32 v170, 0
    v_mov_b32 v171, 0
    v_mov_b32 v172, 0
    v_mov_b32 v173, 0
    v_mov_b32 v174, 0
    v_mov_b32 v175, 0
    v_mov_b32 v176, 0
    v_mov_b32 v177, 0
    v_mov_b32 v178, 0
    v_mov_b32 v179, 0
    v_mov_b32 v180, 0
    v_mov_b32 v181, 0
    v_mov_b32 v182, 0
    v_mov_b32 v183, 0
    s_waitcnt vmcnt(10)
    s_barrier
    ds_read_b128 v[72:75], v17 offset:0
    ds_read_b64_tr_b16 v[24:25], v13 offset:0
    ds_read_b64_tr_b16 v[26:27], v13 offset:768
    ds_read_b64_tr_b16 v[28:29], v13 offset:256
    ds_read_b64_tr_b16 v[30:31], v13 offset:1024
    ds_read_b64_tr_b16 v[32:33], v13 offset:512
    ds_read_b64_tr_b16 v[34:35], v13 offset:1280
    ds_read_b64_tr_b16 v[36:37], v13 offset:6144
    ds_read_b64_tr_b16 v[38:39], v13 offset:6912
    ds_read_b64_tr_b16 v[40:41], v13 offset:6400
    ds_read_b64_tr_b16 v[42:43], v13 offset:7168
    ds_read_b64_tr_b16 v[44:45], v13 offset:6656
    ds_read_b64_tr_b16 v[46:47], v13 offset:7424
    s_waitcnt lgkmcnt(10)
    v_mfma_f32_32x32x16_bf16 v[88:103], v[24:27], v[72:75], v[88:103]
    ds_read_b128 v[76:79], v18 offset:0
    ds_read_b64_tr_b16 v[48:49], v13 offset:3072
    ds_read_b64_tr_b16 v[50:51], v13 offset:3840
    s_waitcnt lgkmcnt(11)
    v_mfma_f32_32x32x16_bf16 v[104:119], v[28:31], v[72:75], v[104:119]
    ds_read_b64_tr_b16 v[52:53], v13 offset:3328
    ds_read_b64_tr_b16 v[54:55], v13 offset:4096
    s_waitcnt lgkmcnt(11)
    v_mfma_f32_32x32x16_bf16 v[120:135], v[32:35], v[72:75], v[120:135]
    ds_read_b64_tr_b16 v[56:57], v13 offset:3584
    ds_read_b64_tr_b16 v[58:59], v13 offset:4352
    s_waitcnt lgkmcnt(11)
    v_mfma_f32_32x32x16_bf16 v[136:151], v[36:39], v[72:75], v[136:151]
    ds_read_b64_tr_b16 v[60:61], v13 offset:9216
    ds_read_b64_tr_b16 v[62:63], v13 offset:9984
    s_mov_b32 s8, 264192
    s_add_u32 m0, s14, 61440
    s_nop 0
    buffer_load_dwordx4 v5, s[56:59], s8 offen lds
    s_waitcnt lgkmcnt(11)
    v_mfma_f32_32x32x16_bf16 v[152:167], v[40:43], v[72:75], v[152:167]
    ds_read_b64_tr_b16 v[64:65], v13 offset:9472
    ds_read_b64_tr_b16 v[66:67], v13 offset:10240
    s_mov_b32 s8, 264192
    s_add_u32 m0, s14, 62464
    s_nop 0
    buffer_load_dwordx4 v6, s[56:59], s8 offen lds
    s_waitcnt lgkmcnt(11)
    v_mfma_f32_32x32x16_bf16 v[168:183], v[44:47], v[72:75], v[168:183]
    ds_read_b64_tr_b16 v[68:69], v13 offset:9728
    ds_read_b64_tr_b16 v[70:71], v13 offset:10496
    s_mov_b32 s8, 264192
    s_add_u32 m0, s14, 63488
    s_nop 0
    buffer_load_dwordx4 v7, s[56:59], s8 offen lds
    s_waitcnt lgkmcnt(10)
    v_mfma_f32_32x32x16_bf16 v[88:103], v[48:51], v[76:79], v[88:103]
    s_mov_b32 s8, 192
    s_add_u32 m0, s15, 61440
    s_nop 0
    buffer_load_dwordx4 v8, s[48:51], s8 offen lds
    s_waitcnt lgkmcnt(8)
    v_mfma_f32_32x32x16_bf16 v[104:119], v[52:55], v[76:79], v[104:119]
    s_mov_b32 s8, 192
    s_add_u32 m0, s15, 62464
    s_nop 0
    buffer_load_dwordx4 v9, s[48:51], s8 offen lds
    s_waitcnt lgkmcnt(6)
    v_mfma_f32_32x32x16_bf16 v[120:135], v[56:59], v[76:79], v[120:135]
    s_waitcnt lgkmcnt(4)
    v_mfma_f32_32x32x16_bf16 v[136:151], v[60:63], v[76:79], v[136:151]
    s_waitcnt lgkmcnt(2)
    v_mfma_f32_32x32x16_bf16 v[152:167], v[64:67], v[76:79], v[152:167]
    s_waitcnt lgkmcnt(0)
    v_mfma_f32_32x32x16_bf16 v[168:183], v[68:71], v[76:79], v[168:183]
    s_waitcnt vmcnt(10)
    s_barrier
    ds_read_b128 v[72:75], v17 offset:20480
    ds_read_b64_tr_b16 v[24:25], v13 offset:20480
    ds_read_b64_tr_b16 v[26:27], v13 offset:21248
    ds_read_b64_tr_b16 v[28:29], v13 offset:20736
    ds_read_b64_tr_b16 v[30:31], v13 offset:21504
    ds_read_b64_tr_b16 v[32:33], v13 offset:20992
    ds_read_b64_tr_b16 v[34:35], v13 offset:21760
    ds_read_b64_tr_b16 v[36:37], v13 offset:26624
    ds_read_b64_tr_b16 v[38:39], v13 offset:27392
    ds_read_b64_tr_b16 v[40:41], v13 offset:26880
    ds_read_b64_tr_b16 v[42:43], v13 offset:27648
    ds_read_b64_tr_b16 v[44:45], v13 offset:27136
    ds_read_b64_tr_b16 v[46:47], v13 offset:27904
    s_waitcnt lgkmcnt(10)
    v_mfma_f32_32x32x16_bf16 v[88:103], v[24:27], v[72:75], v[88:103]
    ds_read_b128 v[76:79], v18 offset:20480
    ds_read_b64_tr_b16 v[48:49], v13 offset:23552
    ds_read_b64_tr_b16 v[50:51], v13 offset:24320
    s_waitcnt lgkmcnt(11)
    v_mfma_f32_32x32x16_bf16 v[104:119], v[28:31], v[72:75], v[104:119]
    ds_read_b64_tr_b16 v[52:53], v13 offset:23808
    ds_read_b64_tr_b16 v[54:55], v13 offset:24576
    s_waitcnt lgkmcnt(11)
    v_mfma_f32_32x32x16_bf16 v[120:135], v[32:35], v[72:75], v[120:135]
    ds_read_b64_tr_b16 v[56:57], v13 offset:24064
    ds_read_b64_tr_b16 v[58:59], v13 offset:24832
    s_waitcnt lgkmcnt(11)
    v_mfma_f32_32x32x16_bf16 v[136:151], v[36:39], v[72:75], v[136:151]
    ds_read_b64_tr_b16 v[60:61], v13 offset:29696
    ds_read_b64_tr_b16 v[62:63], v13 offset:30464
    s_mov_b32 s8, 352256
    s_add_u32 m0, s14, 0
    s_nop 0
    buffer_load_dwordx4 v5, s[56:59], s8 offen lds
    s_waitcnt lgkmcnt(11)
    v_mfma_f32_32x32x16_bf16 v[152:167], v[40:43], v[72:75], v[152:167]
    ds_read_b64_tr_b16 v[64:65], v13 offset:29952
    ds_read_b64_tr_b16 v[66:67], v13 offset:30720
    s_mov_b32 s8, 352256
    s_add_u32 m0, s14, 1024
    s_nop 0
    buffer_load_dwordx4 v6, s[56:59], s8 offen lds
    s_waitcnt lgkmcnt(11)
    v_mfma_f32_32x32x16_bf16 v[168:183], v[44:47], v[72:75], v[168:183]
    ds_read_b64_tr_b16 v[68:69], v13 offset:30208
    ds_read_b64_tr_b16 v[70:71], v13 offset:30976
    s_mov_b32 s8, 352256
    s_add_u32 m0, s14, 2048
    s_nop 0
    buffer_load_dwordx4 v7, s[56:59], s8 offen lds
    s_waitcnt lgkmcnt(10)
    v_mfma_f32_32x32x16_bf16 v[88:103], v[48:51], v[76:79], v[88:103]
    s_mov_b32 s8, 256
    s_add_u32 m0, s15, 0
    s_nop 0
    buffer_load_dwordx4 v8, s[48:51], s8 offen lds
    s_waitcnt lgkmcnt(8)
    v_mfma_f32_32x32x16_bf16 v[104:119], v[52:55], v[76:79], v[104:119]
    s_mov_b32 s8, 256
    s_add_u32 m0, s15, 1024
    s_nop 0
    buffer_load_dwordx4 v9, s[48:51], s8 offen lds
    s_waitcnt lgkmcnt(6)
    v_mfma_f32_32x32x16_bf16 v[120:135], v[56:59], v[76:79], v[120:135]
    s_waitcnt lgkmcnt(4)
    v_mfma_f32_32x32x16_bf16 v[136:151], v[60:63], v[76:79], v[136:151]
    s_waitcnt lgkmcnt(2)
    v_mfma_f32_32x32x16_bf16 v[152:167], v[64:67], v[76:79], v[152:167]
    s_waitcnt lgkmcnt(0)
    v_mfma_f32_32x32x16_bf16 v[168:183], v[68:71], v[76:79], v[168:183]
    s_waitcnt vmcnt(10)
    s_barrier
    ds_read_b128 v[72:75], v19 offset:0
    ds_read_b64_tr_b16 v[24:25], v14 offset:0
    ds_read_b64_tr_b16 v[26:27], v14 offset:768
    ds_read_b64_tr_b16 v[28:29], v14 offset:256
    ds_read_b64_tr_b16 v[30:31], v14 offset:1024
    ds_read_b64_tr_b16 v[32:33], v14 offset:512
    ds_read_b64_tr_b16 v[34:35], v14 offset:1280
    ds_read_b64_tr_b16 v[36:37], v14 offset:6144
    ds_read_b64_tr_b16 v[38:39], v14 offset:6912
    ds_read_b64_tr_b16 v[40:41], v14 offset:6400
    ds_read_b64_tr_b16 v[42:43], v14 offset:7168
    ds_read_b64_tr_b16 v[44:45], v14 offset:6656
    ds_read_b64_tr_b16 v[46:47], v14 offset:7424
    s_waitcnt lgkmcnt(10)
    v_mfma_f32_32x32x16_bf16 v[88:103], v[24:27], v[72:75], v[88:103]
    ds_read_b128 v[76:79], v20 offset:0
    ds_read_b64_tr_b16 v[48:49], v14 offset:3072
    ds_read_b64_tr_b16 v[50:51], v14 offset:3840
    s_waitcnt lgkmcnt(11)
    v_mfma_f32_32x32x16_bf16 v[104:119], v[28:31], v[72:75], v[104:119]
    ds_read_b64_tr_b16 v[52:53], v14 offset:3328
    ds_read_b64_tr_b16 v[54:55], v14 offset:4096
    s_waitcnt lgkmcnt(11)
    v_mfma_f32_32x32x16_bf16 v[120:135], v[32:35], v[72:75], v[120:135]
    ds_read_b64_tr_b16 v[56:57], v14 offset:3584
    ds_read_b64_tr_b16 v[58:59], v14 offset:4352
    s_waitcnt lgkmcnt(11)
    v_mfma_f32_32x32x16_bf16 v[136:151], v[36:39], v[72:75], v[136:151]
    ds_read_b64_tr_b16 v[60:61], v14 offset:9216
    ds_read_b64_tr_b16 v[62:63], v14 offset:9984
    s_mov_b32 s8, 440320
    s_add_u32 m0, s14, 20480
    s_nop 0
    buffer_load_dwordx4 v5, s[56:59], s8 offen lds
    s_waitcnt lgkmcnt(11)
    v_mfma_f32_32x32x16_bf16 v[152:167], v[40:43], v[72:75], v[152:167]
    ds_read_b64_tr_b16 v[64:65], v14 offset:9472
    ds_read_b64_tr_b16 v[66:67], v14 offset:10240
    s_mov_b32 s8, 440320
    s_add_u32 m0, s14, 21504
    s_nop 0
    buffer_load_dwordx4 v6, s[56:59], s8 offen lds
    s_waitcnt lgkmcnt(11)
    v_mfma_f32_32x32x16_bf16 v[168:183], v[44:47], v[72:75], v[168:183]
    ds_read_b64_tr_b16 v[68:69], v14 offset:9728
    ds_read_b64_tr_b16 v[70:71], v14 offset:10496
    s_mov_b32 s8, 440320
    s_add_u32 m0, s14, 22528
    s_nop 0
    buffer_load_dwordx4 v7, s[56:59], s8 offen lds
    s_waitcnt lgkmcnt(10)
    v_mfma_f32_32x32x16_bf16 v[88:103], v[48:51], v[76:79], v[88:103]
    s_mov_b32 s8, 320
    s_add_u32 m0, s15, 20480
    s_nop 0
    buffer_load_dwordx4 v8, s[48:51], s8 offen lds
    s_waitcnt lgkmcnt(8)
    v_mfma_f32_32x32x16_bf16 v[104:119], v[52:55], v[76:79], v[104:119]
    s_mov_b32 s8, 320
    s_add_u32 m0, s15, 21504
    s_nop 0
    buffer_load_dwordx4 v9, s[48:51], s8 offen lds
    s_waitcnt lgkmcnt(6)
    v_mfma_f32_32x32x16_bf16 v[120:135], v[56:59], v[76:79], v[120:135]
    s_waitcnt lgkmcnt(4)
    v_mfma_f32_32x32x16_bf16 v[136:151], v[60:63], v[76:79], v[136:151]
    s_waitcnt lgkmcnt(2)
    v_mfma_f32_32x32x16_bf16 v[152:167], v[64:67], v[76:79], v[152:167]
    s_waitcnt lgkmcnt(0)
    v_mfma_f32_32x32x16_bf16 v[168:183], v[68:71], v[76:79], v[168:183]
    s_waitcnt vmcnt(10)
    s_barrier
    ds_read_b128 v[72:75], v19 offset:20480
    ds_read_b64_tr_b16 v[24:25], v14 offset:20480
    ds_read_b64_tr_b16 v[26:27], v14 offset:21248
    ds_read_b64_tr_b16 v[28:29], v14 offset:20736
    ds_read_b64_tr_b16 v[30:31], v14 offset:21504
    ds_read_b64_tr_b16 v[32:33], v14 offset:20992
    ds_read_b64_tr_b16 v[34:35], v14 offset:21760
    ds_read_b64_tr_b16 v[36:37], v14 offset:26624
    ds_read_b64_tr_b16 v[38:39], v14 offset:27392
    ds_read_b64_tr_b16 v[40:41], v14 offset:26880
    ds_read_b64_tr_b16 v[42:43], v14 offset:27648
    ds_read_b64_tr_b16 v[44:45], v14 offset:27136
    ds_read_b64_tr_b16 v[46:47], v14 offset:27904
    s_waitcnt lgkmcnt(10)
    v_mfma_f32_32x32x16_bf16 v[88:103], v[24:27], v[72:75], v[88:103]
    ds_read_b128 v[76:79], v20 offset:20480
    ds_read_b64_tr_b16 v[48:49], v14 offset:23552
    ds_read_b64_tr_b16 v[50:51], v14 offset:24320
    s_waitcnt lgkmcnt(11)
    v_mfma_f32_32x32x16_bf16 v[104:119], v[28:31], v[72:75], v[104:119]
    ds_read_b64_tr_b16 v[52:53], v14 offset:23808
    ds_read_b64_tr_b16 v[54:55], v14 offset:24576
    s_waitcnt lgkmcnt(11)
    v_mfma_f32_32x32x16_bf16 v[120:135], v[32:35], v[72:75], v[120:135]
    ds_read_b64_tr_b16 v[56:57], v14 offset:24064
    ds_read_b64_tr_b16 v[58:59], v14 offset:24832
    s_waitcnt lgkmcnt(11)
    v_mfma_f32_32x32x16_bf16 v[136:151], v[36:39], v[72:75], v[136:151]
    ds_read_b64_tr_b16 v[60:61], v14 offset:29696
    ds_read_b64_tr_b16 v[62:63], v14 offset:30464
    s_mov_b32 s8, 528384
    s_add_u32 m0, s14, 40960
    s_nop 0
    buffer_load_dwordx4 v5, s[56:59], s8 offen lds
    s_waitcnt lgkmcnt(11)
    v_mfma_f32_32x32x16_bf16 v[152:167], v[40:43], v[72:75], v[152:167]
    ds_read_b64_tr_b16 v[64:65], v14 offset:29952
    ds_read_b64_tr_b16 v[66:67], v14 offset:30720
    s_mov_b32 s8, 528384
    s_add_u32 m0, s14, 41984
    s_nop 0
    buffer_load_dwordx4 v6, s[56:59], s8 offen lds
    s_waitcnt lgkmcnt(11)
    v_mfma_f32_32x32x16_bf16 v[168:183], v[44:47], v[72:75], v[168:183]
    ds_read_b64_tr_b16 v[68:69], v14 offset:30208
    ds_read_b64_tr_b16 v[70:71], v14 offset:30976
    s_mov_b32 s8, 528384
    s_add_u32 m0, s14, 43008
    s_nop 0
    buffer_load_dwordx4 v7, s[56:59], s8 offen lds
    s_waitcnt lgkmcnt(10)
    v_mfma_f32_32x32x16_bf16 v[88:103], v[48:51], v[76:79], v[88:103]
    s_mov_b32 s8, 384
    s_add_u32 m0, s15, 40960
    s_nop 0
    buffer_load_dwordx4 v8, s[48:51], s8 offen lds
    s_waitcnt lgkmcnt(8)
    v_mfma_f32_32x32x16_bf16 v[104:119], v[52:55], v[76:79], v[104:119]
    s_mov_b32 s8, 384
    s_add_u32 m0, s15, 41984
    s_nop 0
    buffer_load_dwordx4 v9, s[48:51], s8 offen lds
    s_waitcnt lgkmcnt(6)
    v_mfma_f32_32x32x16_bf16 v[120:135], v[56:59], v[76:79], v[120:135]
    s_waitcnt lgkmcnt(4)
    v_mfma_f32_32x32x16_bf16 v[136:151], v[60:63], v[76:79], v[136:151]
    s_waitcnt lgkmcnt(2)
    v_mfma_f32_32x32x16_bf16 v[152:167], v[64:67], v[76:79], v[152:167]
    s_waitcnt lgkmcnt(0)
    v_mfma_f32_32x32x16_bf16 v[168:183], v[68:71], v[76:79], v[168:183]
    s_waitcnt vmcnt(10)
    s_barrier
    ds_read_b128 v[72:75], v17 offset:0
    ds_read_b64_tr_b16 v[24:25], v13 offset:0
    ds_read_b64_tr_b16 v[26:27], v13 offset:768
    ds_read_b64_tr_b16 v[28:29], v13 offset:256
    ds_read_b64_tr_b16 v[30:31], v13 offset:1024
    ds_read_b64_tr_b16 v[32:33], v13 offset:512
    ds_read_b64_tr_b16 v[34:35], v13 offset:1280
    ds_read_b64_tr_b16 v[36:37], v13 offset:6144
    ds_read_b64_tr_b16 v[38:39], v13 offset:6912
    ds_read_b64_tr_b16 v[40:41], v13 offset:6400
    ds_read_b64_tr_b16 v[42:43], v13 offset:7168
    ds_read_b64_tr_b16 v[44:45], v13 offset:6656
    ds_read_b64_tr_b16 v[46:47], v13 offset:7424
    s_waitcnt lgkmcnt(10)
    v_mfma_f32_32x32x16_bf16 v[88:103], v[24:27], v[72:75], v[88:103]
    ds_read_b128 v[76:79], v18 offset:0
    ds_read_b64_tr_b16 v[48:49], v13 offset:3072
    ds_read_b64_tr_b16 v[50:51], v13 offset:3840
    s_waitcnt lgkmcnt(11)
    v_mfma_f32_32x32x16_bf16 v[104:119], v[28:31], v[72:75], v[104:119]
    ds_read_b64_tr_b16 v[52:53], v13 offset:3328
    ds_read_b64_tr_b16 v[54:55], v13 offset:4096
    s_waitcnt lgkmcnt(11)
    v_mfma_f32_32x32x16_bf16 v[120:135], v[32:35], v[72:75], v[120:135]
    ds_read_b64_tr_b16 v[56:57], v13 offset:3584
    ds_read_b64_tr_b16 v[58:59], v13 offset:4352
    s_waitcnt lgkmcnt(11)
    v_mfma_f32_32x32x16_bf16 v[136:151], v[36:39], v[72:75], v[136:151]
    ds_read_b64_tr_b16 v[60:61], v13 offset:9216
    ds_read_b64_tr_b16 v[62:63], v13 offset:9984
    s_mov_b32 s8, 616448
    s_add_u32 m0, s14, 61440
    s_nop 0
    buffer_load_dwordx4 v5, s[56:59], s8 offen lds
    s_waitcnt lgkmcnt(11)
    v_mfma_f32_32x32x16_bf16 v[152:167], v[40:43], v[72:75], v[152:167]
    ds_read_b64_tr_b16 v[64:65], v13 offset:9472
    ds_read_b64_tr_b16 v[66:67], v13 offset:10240
    s_mov_b32 s8, 616448
    s_add_u32 m0, s14, 62464
    s_nop 0
    buffer_load_dwordx4 v6, s[56:59], s8 offen lds
    s_waitcnt lgkmcnt(11)
    v_mfma_f32_32x32x16_bf16 v[168:183], v[44:47], v[72:75], v[168:183]
    ds_read_b64_tr_b16 v[68:69], v13 offset:9728
    ds_read_b64_tr_b16 v[70:71], v13 offset:10496
    s_mov_b32 s8, 616448
    s_add_u32 m0, s14, 63488
    s_nop 0
    buffer_load_dwordx4 v7, s[56:59], s8 offen lds
    s_waitcnt lgkmcnt(10)
    v_mfma_f32_32x32x16_bf16 v[88:103], v[48:51], v[76:79], v[88:103]
    s_mov_b32 s8, 448
    s_add_u32 m0, s15, 61440
    s_nop 0
    buffer_load_dwordx4 v8, s[48:51], s8 offen lds
    s_waitcnt lgkmcnt(8)
    v_mfma_f32_32x32x16_bf16 v[104:119], v[52:55], v[76:79], v[104:119]
    s_mov_b32 s8, 448
    s_add_u32 m0, s15, 62464
    s_nop 0
    buffer_load_dwordx4 v9, s[48:51], s8 offen lds
    s_waitcnt lgkmcnt(6)
    v_mfma_f32_32x32x16_bf16 v[120:135], v[56:59], v[76:79], v[120:135]
    s_waitcnt lgkmcnt(4)
    v_mfma_f32_32x32x16_bf16 v[136:151], v[60:63], v[76:79], v[136:151]
    s_waitcnt lgkmcnt(2)
    v_mfma_f32_32x32x16_bf16 v[152:167], v[64:67], v[76:79], v[152:167]
    s_waitcnt lgkmcnt(0)
    v_mfma_f32_32x32x16_bf16 v[168:183], v[68:71], v[76:79], v[168:183]
    s_waitcnt vmcnt(10)
    s_barrier
    ds_read_b128 v[72:75], v17 offset:20480
    ds_read_b64_tr_b16 v[24:25], v13 offset:20480
    ds_read_b64_tr_b16 v[26:27], v13 offset:21248
    ds_read_b64_tr_b16 v[28:29], v13 offset:20736
    ds_read_b64_tr_b16 v[30:31], v13 offset:21504
    ds_read_b64_tr_b16 v[32:33], v13 offset:20992
    ds_read_b64_tr_b16 v[34:35], v13 offset:21760
    ds_read_b64_tr_b16 v[36:37], v13 offset:26624
    ds_read_b64_tr_b16 v[38:39], v13 offset:27392
    ds_read_b64_tr_b16 v[40:41], v13 offset:26880
    ds_read_b64_tr_b16 v[42:43], v13 offset:27648
    ds_read_b64_tr_b16 v[44:45], v13 offset:27136
    ds_read_b64_tr_b16 v[46:47], v13 offset:27904
    s_waitcnt lgkmcnt(10)
    v_mfma_f32_32x32x16_bf16 v[88:103], v[24:27], v[72:75], v[88:103]
    ds_read_b128 v[76:79], v18 offset:20480
    ds_read_b64_tr_b16 v[48:49], v13 offset:23552
    ds_read_b64_tr_b16 v[50:51], v13 offset:24320
    s_waitcnt lgkmcnt(11)
    v_mfma_f32_32x32x16_bf16 v[104:119], v[28:31], v[72:75], v[104:119]
    ds_read_b64_tr_b16 v[52:53], v13 offset:23808
    ds_read_b64_tr_b16 v[54:55], v13 offset:24576
    s_waitcnt lgkmcnt(11)
    v_mfma_f32_32x32x16_bf16 v[120:135], v[32:35], v[72:75], v[120:135]
    ds_read_b64_tr_b16 v[56:57], v13 offset:24064
    ds_read_b64_tr_b16 v[58:59], v13 offset:24832
    s_waitcnt lgkmcnt(11)
    v_mfma_f32_32x32x16_bf16 v[136:151], v[36:39], v[72:75], v[136:151]
    ds_read_b64_tr_b16 v[60:61], v13 offset:29696
    ds_read_b64_tr_b16 v[62:63], v13 offset:30464
    s_mov_b32 s8, 704512
    s_add_u32 m0, s14, 0
    s_nop 0
    buffer_load_dwordx4 v5, s[56:59], s8 offen lds
    s_waitcnt lgkmcnt(11)
    v_mfma_f32_32x32x16_bf16 v[152:167], v[40:43], v[72:75], v[152:167]
    ds_read_b64_tr_b16 v[64:65], v13 offset:29952
    ds_read_b64_tr_b16 v[66:67], v13 offset:30720
    s_mov_b32 s8, 704512
    s_add_u32 m0, s14, 1024
    s_nop 0
    buffer_load_dwordx4 v6, s[56:59], s8 offen lds
    s_waitcnt lgkmcnt(11)
    v_mfma_f32_32x32x16_bf16 v[168:183], v[44:47], v[72:75], v[168:183]
    ds_read_b64_tr_b16 v[68:69], v13 offset:30208
    ds_read_b64_tr_b16 v[70:71], v13 offset:30976
    s_mov_b32 s8, 704512
    s_add_u32 m0, s14, 2048
    s_nop 0
    buffer_load_dwordx4 v7, s[56:59], s8 offen lds
    s_waitcnt lgkmcnt(10)
    v_mfma_f32_32x32x16_bf16 v[88:103], v[48:51], v[76:79], v[88:103]
    s_mov_b32 s8, 512
    s_add_u32 m0, s15, 0
    s_nop 0
    buffer_load_dwordx4 v8, s[48:51], s8 offen lds
    s_waitcnt lgkmcnt(8)
    v_mfma_f32_32x32x16_bf16 v[104:119], v[52:55], v[76:79], v[104:119]
    s_mov_b32 s8, 512
    s_add_u32 m0, s15, 1024
    s_nop 0
    buffer_load_dwordx4 v9, s[48:51], s8 offen lds
    s_waitcnt lgkmcnt(6)
    v_mfma_f32_32x32x16_bf16 v[120:135], v[56:59], v[76:79], v[120:135]
    s_waitcnt lgkmcnt(4)
    v_mfma_f32_32x32x16_bf16 v[136:151], v[60:63], v[76:79], v[136:151]
    s_waitcnt lgkmcnt(2)
    v_mfma_f32_32x32x16_bf16 v[152:167], v[64:67], v[76:79], v[152:167]
    s_waitcnt lgkmcnt(0)
    v_mfma_f32_32x32x16_bf16 v[168:183], v[68:71], v[76:79], v[168:183]
    s_waitcnt vmcnt(10)
    s_barrier
    ds_read_b128 v[72:75], v19 offset:0
    ds_read_b64_tr_b16 v[24:25], v14 offset:0
    ds_read_b64_tr_b16 v[26:27], v14 offset:768
    ds_read_b64_tr_b16 v[28:29], v14 offset:256
    ds_read_b64_tr_b16 v[30:31], v14 offset:1024
    ds_read_b64_tr_b16 v[32:33], v14 offset:512
    ds_read_b64_tr_b16 v[34:35], v14 offset:1280
    ds_read_b64_tr_b16 v[36:37], v14 offset:6144
    ds_read_b64_tr_b16 v[38:39], v14 offset:6912
    ds_read_b64_tr_b16 v[40:41], v14 offset:6400
    ds_read_b64_tr_b16 v[42:43], v14 offset:7168
    ds_read_b64_tr_b16 v[44:45], v14 offset:6656
    ds_read_b64_tr_b16 v[46:47], v14 offset:7424
    s_waitcnt lgkmcnt(10)
    v_mfma_f32_32x32x16_bf16 v[88:103], v[24:27], v[72:75], v[88:103]
    ds_read_b128 v[76:79], v20 offset:0
    ds_read_b64_tr_b16 v[48:49], v14 offset:3072
    ds_read_b64_tr_b16 v[50:51], v14 offset:3840
    s_waitcnt lgkmcnt(11)
    v_mfma_f32_32x32x16_bf16 v[104:119], v[28:31], v[72:75], v[104:119]
    ds_read_b64_tr_b16 v[52:53], v14 offset:3328
    ds_read_b64_tr_b16 v[54:55], v14 offset:4096
    s_waitcnt lgkmcnt(11)
    v_mfma_f32_32x32x16_bf16 v[120:135], v[32:35], v[72:75], v[120:135]
    ds_read_b64_tr_b16 v[56:57], v14 offset:3584
    ds_read_b64_tr_b16 v[58:59], v14 offset:4352
    s_waitcnt lgkmcnt(11)
    v_mfma_f32_32x32x16_bf16 v[136:151], v[36:39], v[72:75], v[136:151]
    ds_read_b64_tr_b16 v[60:61], v14 offset:9216
    ds_read_b64_tr_b16 v[62:63], v14 offset:9984
    s_mov_b32 s8, 792576
    s_add_u32 m0, s14, 20480
    s_nop 0
    buffer_load_dwordx4 v5, s[56:59], s8 offen lds
    s_waitcnt lgkmcnt(11)
    v_mfma_f32_32x32x16_bf16 v[152:167], v[40:43], v[72:75], v[152:167]
    ds_read_b64_tr_b16 v[64:65], v14 offset:9472
    ds_read_b64_tr_b16 v[66:67], v14 offset:10240
    s_mov_b32 s8, 792576
    s_add_u32 m0, s14, 21504
    s_nop 0
    buffer_load_dwordx4 v6, s[56:59], s8 offen lds
    s_waitcnt lgkmcnt(11)
    v_mfma_f32_32x32x16_bf16 v[168:183], v[44:47], v[72:75], v[168:183]
    ds_read_b64_tr_b16 v[68:69], v14 offset:9728
    ds_read_b64_tr_b16 v[70:71], v14 offset:10496
    s_mov_b32 s8, 792576
    s_add_u32 m0, s14, 22528
    s_nop 0
    buffer_load_dwordx4 v7, s[56:59], s8 offen lds
    s_waitcnt lgkmcnt(10)
    v_mfma_f32_32x32x16_bf16 v[88:103], v[48:51], v[76:79], v[88:103]
    s_mov_b32 s8, 576
    s_add_u32 m0, s15, 20480
    s_nop 0
    buffer_load_dwordx4 v8, s[48:51], s8 offen lds
    s_waitcnt lgkmcnt(8)
    v_mfma_f32_32x32x16_bf16 v[104:119], v[52:55], v[76:79], v[104:119]
    s_mov_b32 s8, 576
    s_add_u32 m0, s15, 21504
    s_nop 0
    buffer_load_dwordx4 v9, s[48:51], s8 offen lds
    s_waitcnt lgkmcnt(6)
    v_mfma_f32_32x32x16_bf16 v[120:135], v[56:59], v[76:79], v[120:135]
    s_waitcnt lgkmcnt(4)
    v_mfma_f32_32x32x16_bf16 v[136:151], v[60:63], v[76:79], v[136:151]
    s_waitcnt lgkmcnt(2)
    v_mfma_f32_32x32x16_bf16 v[152:167], v[64:67], v[76:79], v[152:167]
    s_waitcnt lgkmcnt(0)
    v_mfma_f32_32x32x16_bf16 v[168:183], v[68:71], v[76:79], v[168:183]
    s_waitcnt vmcnt(10)
    s_barrier
    ds_read_b128 v[72:75], v19 offset:20480
    ds_read_b64_tr_b16 v[24:25], v14 offset:20480
    ds_read_b64_tr_b16 v[26:27], v14 offset:21248
    ds_read_b64_tr_b16 v[28:29], v14 offset:20736
    ds_read_b64_tr_b16 v[30:31], v14 offset:21504
    ds_read_b64_tr_b16 v[32:33], v14 offset:20992
    ds_read_b64_tr_b16 v[34:35], v14 offset:21760
    ds_read_b64_tr_b16 v[36:37], v14 offset:26624
    ds_read_b64_tr_b16 v[38:39], v14 offset:27392
    ds_read_b64_tr_b16 v[40:41], v14 offset:26880
    ds_read_b64_tr_b16 v[42:43], v14 offset:27648
    ds_read_b64_tr_b16 v[44:45], v14 offset:27136
    ds_read_b64_tr_b16 v[46:47], v14 offset:27904
    s_waitcnt lgkmcnt(10)
    v_mfma_f32_32x32x16_bf16 v[88:103], v[24:27], v[72:75], v[88:103]
    ds_read_b128 v[76:79], v20 offset:20480
    ds_read_b64_tr_b16 v[48:49], v14 offset:23552
    ds_read_b64_tr_b16 v[50:51], v14 offset:24320
    s_waitcnt lgkmcnt(11)
    v_mfma_f32_32x32x16_bf16 v[104:119], v[28:31], v[72:75], v[104:119]
    ds_read_b64_tr_b16 v[52:53], v14 offset:23808
    ds_read_b64_tr_b16 v[54:55], v14 offset:24576
    s_waitcnt lgkmcnt(11)
    v_mfma_f32_32x32x16_bf16 v[120:135], v[32:35], v[72:75], v[120:135]
    ds_read_b64_tr_b16 v[56:57], v14 offset:24064
    ds_read_b64_tr_b16 v[58:59], v14 offset:24832
    s_waitcnt lgkmcnt(11)
    v_mfma_f32_32x32x16_bf16 v[136:151], v[36:39], v[72:75], v[136:151]
    ds_read_b64_tr_b16 v[60:61], v14 offset:29696
    ds_read_b64_tr_b16 v[62:63], v14 offset:30464
    s_mov_b32 s8, 880640
    s_add_u32 m0, s14, 40960
    s_nop 0
    buffer_load_dwordx4 v5, s[56:59], s8 offen lds
    s_waitcnt lgkmcnt(11)
    v_mfma_f32_32x32x16_bf16 v[152:167], v[40:43], v[72:75], v[152:167]
    ds_read_b64_tr_b16 v[64:65], v14 offset:29952
    ds_read_b64_tr_b16 v[66:67], v14 offset:30720
    s_mov_b32 s8, 880640
    s_add_u32 m0, s14, 41984
    s_nop 0
    buffer_load_dwordx4 v6, s[56:59], s8 offen lds
    s_waitcnt lgkmcnt(11)
    v_mfma_f32_32x32x16_bf16 v[168:183], v[44:47], v[72:75], v[168:183]
    ds_read_b64_tr_b16 v[68:69], v14 offset:30208
    ds_read_b64_tr_b16 v[70:71], v14 offset:30976
    s_mov_b32 s8, 880640
    s_add_u32 m0, s14, 43008
    s_nop 0
    buffer_load_dwordx4 v7, s[56:59], s8 offen lds
    s_waitcnt lgkmcnt(10)
    v_mfma_f32_32x32x16_bf16 v[88:103], v[48:51], v[76:79], v[88:103]
    s_mov_b32 s8, 640
    s_add_u32 m0, s15, 40960
    s_nop 0
    buffer_load_dwordx4 v8, s[48:51], s8 offen lds
    s_waitcnt lgkmcnt(8)
    v_mfma_f32_32x32x16_bf16 v[104:119], v[52:55], v[76:79], v[104:119]
    s_mov_b32 s8, 640
    s_add_u32 m0, s15, 41984
    s_nop 0
    buffer_load_dwordx4 v9, s[48:51], s8 offen lds
    s_waitcnt lgkmcnt(6)
    v_mfma_f32_32x32x16_bf16 v[120:135], v[56:59], v[76:79], v[120:135]
    s_waitcnt lgkmcnt(4)
    v_mfma_f32_32x32x16_bf16 v[136:151], v[60:63], v[76:79], v[136:151]
    s_waitcnt lgkmcnt(2)
    v_mfma_f32_32x32x16_bf16 v[152:167], v[64:67], v[76:79], v[152:167]
    s_waitcnt lgkmcnt(0)
    v_mfma_f32_32x32x16_bf16 v[168:183], v[68:71], v[76:79], v[168:183]
    s_waitcnt vmcnt(10)
    s_barrier
    ds_read_b128 v[72:75], v17 offset:0
    ds_read_b64_tr_b16 v[24:25], v13 offset:0
    ds_read_b64_tr_b16 v[26:27], v13 offset:768
    ds_read_b64_tr_b16 v[28:29], v13 offset:256
    ds_read_b64_tr_b16 v[30:31], v13 offset:1024
    ds_read_b64_tr_b16 v[32:33], v13 offset:512
    ds_read_b64_tr_b16 v[34:35], v13 offset:1280
    ds_read_b64_tr_b16 v[36:37], v13 offset:6144
    ds_read_b64_tr_b16 v[38:39], v13 offset:6912
    ds_read_b64_tr_b16 v[40:41], v13 offset:6400
    ds_read_b64_tr_b16 v[42:43], v13 offset:7168
    ds_read_b64_tr_b16 v[44:45], v13 offset:6656
    ds_read_b64_tr_b16 v[46:47], v13 offset:7424
    s_waitcnt lgkmcnt(10)
    v_mfma_f32_32x32x16_bf16 v[88:103], v[24:27], v[72:75], v[88:103]
    ds_read_b128 v[76:79], v18 offset:0
    ds_read_b64_tr_b16 v[48:49], v13 offset:3072
    ds_read_b64_tr_b16 v[50:51], v13 offset:3840
    s_waitcnt lgkmcnt(11)
    v_mfma_f32_32x32x16_bf16 v[104:119], v[28:31], v[72:75], v[104:119]
    ds_read_b64_tr_b16 v[52:53], v13 offset:3328
    ds_read_b64_tr_b16 v[54:55], v13 offset:4096
    s_waitcnt lgkmcnt(11)
    v_mfma_f32_32x32x16_bf16 v[120:135], v[32:35], v[72:75], v[120:135]
    ds_read_b64_tr_b16 v[56:57], v13 offset:3584
    ds_read_b64_tr_b16 v[58:59], v13 offset:4352
    s_waitcnt lgkmcnt(11)
    v_mfma_f32_32x32x16_bf16 v[136:151], v[36:39], v[72:75], v[136:151]
    ds_read_b64_tr_b16 v[60:61], v13 offset:9216
    ds_read_b64_tr_b16 v[62:63], v13 offset:9984
    s_mov_b32 s8, 968704
    s_add_u32 m0, s14, 61440
    s_nop 0
    buffer_load_dwordx4 v5, s[56:59], s8 offen lds
    s_waitcnt lgkmcnt(11)
    v_mfma_f32_32x32x16_bf16 v[152:167], v[40:43], v[72:75], v[152:167]
    ds_read_b64_tr_b16 v[64:65], v13 offset:9472
    ds_read_b64_tr_b16 v[66:67], v13 offset:10240
    s_mov_b32 s8, 968704
    s_add_u32 m0, s14, 62464
    s_nop 0
    buffer_load_dwordx4 v6, s[56:59], s8 offen lds
    s_waitcnt lgkmcnt(11)
    v_mfma_f32_32x32x16_bf16 v[168:183], v[44:47], v[72:75], v[168:183]
    ds_read_b64_tr_b16 v[68:69], v13 offset:9728
    ds_read_b64_tr_b16 v[70:71], v13 offset:10496
    s_mov_b32 s8, 968704
    s_add_u32 m0, s14, 63488
    s_nop 0
    buffer_load_dwordx4 v7, s[56:59], s8 offen lds
    s_waitcnt lgkmcnt(10)
    v_mfma_f32_32x32x16_bf16 v[88:103], v[48:51], v[76:79], v[88:103]
    s_mov_b32 s8, 704
    s_add_u32 m0, s15, 61440
    s_nop 0
    buffer_load_dwordx4 v8, s[48:51], s8 offen lds
    s_waitcnt lgkmcnt(8)
    v_mfma_f32_32x32x16_bf16 v[104:119], v[52:55], v[76:79], v[104:119]
    s_mov_b32 s8, 704
    s_add_u32 m0, s15, 62464
    s_nop 0
    buffer_load_dwordx4 v9, s[48:51], s8 offen lds
    s_waitcnt lgkmcnt(6)
    v_mfma_f32_32x32x16_bf16 v[120:135], v[56:59], v[76:79], v[120:135]
    s_waitcnt lgkmcnt(4)
    v_mfma_f32_32x32x16_bf16 v[136:151], v[60:63], v[76:79], v[136:151]
    s_waitcnt lgkmcnt(2)
    v_mfma_f32_32x32x16_bf16 v[152:167], v[64:67], v[76:79], v[152:167]
    s_waitcnt lgkmcnt(0)
    v_mfma_f32_32x32x16_bf16 v[168:183], v[68:71], v[76:79], v[168:183]
    s_waitcnt vmcnt(10)
    s_barrier
    ds_read_b128 v[72:75], v17 offset:20480
    ds_read_b64_tr_b16 v[24:25], v13 offset:20480
    ds_read_b64_tr_b16 v[26:27], v13 offset:21248
    ds_read_b64_tr_b16 v[28:29], v13 offset:20736
    ds_read_b64_tr_b16 v[30:31], v13 offset:21504
    ds_read_b64_tr_b16 v[32:33], v13 offset:20992
    ds_read_b64_tr_b16 v[34:35], v13 offset:21760
    ds_read_b64_tr_b16 v[36:37], v13 offset:26624
    ds_read_b64_tr_b16 v[38:39], v13 offset:27392
    ds_read_b64_tr_b16 v[40:41], v13 offset:26880
    ds_read_b64_tr_b16 v[42:43], v13 offset:27648
    ds_read_b64_tr_b16 v[44:45], v13 offset:27136
    ds_read_b64_tr_b16 v[46:47], v13 offset:27904
    s_waitcnt lgkmcnt(10)
    v_mfma_f32_32x32x16_bf16 v[88:103], v[24:27], v[72:75], v[88:103]
    ds_read_b128 v[76:79], v18 offset:20480
    ds_read_b64_tr_b16 v[48:49], v13 offset:23552
    ds_read_b64_tr_b16 v[50:51], v13 offset:24320
    s_waitcnt lgkmcnt(11)
    v_mfma_f32_32x32x16_bf16 v[104:119], v[28:31], v[72:75], v[104:119]
    ds_read_b64_tr_b16 v[52:53], v13 offset:23808
    ds_read_b64_tr_b16 v[54:55], v13 offset:24576
    s_waitcnt lgkmcnt(11)
    v_mfma_f32_32x32x16_bf16 v[120:135], v[32:35], v[72:75], v[120:135]
    ds_read_b64_tr_b16 v[56:57], v13 offset:24064
    ds_read_b64_tr_b16 v[58:59], v13 offset:24832
    s_waitcnt lgkmcnt(11)
    v_mfma_f32_32x32x16_bf16 v[136:151], v[36:39], v[72:75], v[136:151]
    ds_read_b64_tr_b16 v[60:61], v13 offset:29696
    ds_read_b64_tr_b16 v[62:63], v13 offset:30464
    s_mov_b32 s8, 1056768
    s_add_u32 m0, s14, 0
    s_nop 0
    buffer_load_dwordx4 v5, s[56:59], s8 offen lds
    s_waitcnt lgkmcnt(11)
    v_mfma_f32_32x32x16_bf16 v[152:167], v[40:43], v[72:75], v[152:167]
    ds_read_b64_tr_b16 v[64:65], v13 offset:29952
    ds_read_b64_tr_b16 v[66:67], v13 offset:30720
    s_mov_b32 s8, 1056768
    s_add_u32 m0, s14, 1024
    s_nop 0
    buffer_load_dwordx4 v6, s[56:59], s8 offen lds
    s_waitcnt lgkmcnt(11)
    v_mfma_f32_32x32x16_bf16 v[168:183], v[44:47], v[72:75], v[168:183]
    ds_read_b64_tr_b16 v[68:69], v13 offset:30208
    ds_read_b64_tr_b16 v[70:71], v13 offset:30976
    s_mov_b32 s8, 1056768
    s_add_u32 m0, s14, 2048
    s_nop 0
    buffer_load_dwordx4 v7, s[56:59], s8 offen lds
    s_waitcnt lgkmcnt(10)
    v_mfma_f32_32x32x16_bf16 v[88:103], v[48:51], v[76:79], v[88:103]
    s_mov_b32 s8, 768
    s_add_u32 m0, s15, 0
    s_nop 0
    buffer_load_dwordx4 v8, s[48:51], s8 offen lds
    s_waitcnt lgkmcnt(8)
    v_mfma_f32_32x32x16_bf16 v[104:119], v[52:55], v[76:79], v[104:119]
    s_mov_b32 s8, 768
    s_add_u32 m0, s15, 1024
    s_nop 0
    buffer_load_dwordx4 v9, s[48:51], s8 offen lds
    s_waitcnt lgkmcnt(6)
    v_mfma_f32_32x32x16_bf16 v[120:135], v[56:59], v[76:79], v[120:135]
    s_waitcnt lgkmcnt(4)
    v_mfma_f32_32x32x16_bf16 v[136:151], v[60:63], v[76:79], v[136:151]
    s_waitcnt lgkmcnt(2)
    v_mfma_f32_32x32x16_bf16 v[152:167], v[64:67], v[76:79], v[152:167]
    s_waitcnt lgkmcnt(0)
    v_mfma_f32_32x32x16_bf16 v[168:183], v[68:71], v[76:79], v[168:183]
    s_waitcnt vmcnt(10)
    s_barrier
    ds_read_b128 v[72:75], v19 offset:0
    ds_read_b64_tr_b16 v[24:25], v14 offset:0
    ds_read_b64_tr_b16 v[26:27], v14 offset:768
    ds_read_b64_tr_b16 v[28:29], v14 offset:256
    ds_read_b64_tr_b16 v[30:31], v14 offset:1024
    ds_read_b64_tr_b16 v[32:33], v14 offset:512
    ds_read_b64_tr_b16 v[34:35], v14 offset:1280
    ds_read_b64_tr_b16 v[36:37], v14 offset:6144
    ds_read_b64_tr_b16 v[38:39], v14 offset:6912
    ds_read_b64_tr_b16 v[40:41], v14 offset:6400
    ds_read_b64_tr_b16 v[42:43], v14 offset:7168
    ds_read_b64_tr_b16 v[44:45], v14 offset:6656
    ds_read_b64_tr_b16 v[46:47], v14 offset:7424
    s_waitcnt lgkmcnt(10)
    v_mfma_f32_32x32x16_bf16 v[88:103], v[24:27], v[72:75], v[88:103]
    ds_read_b128 v[76:79], v20 offset:0
    ds_read_b64_tr_b16 v[48:49], v14 offset:3072
    ds_read_b64_tr_b16 v[50:51], v14 offset:3840
    s_waitcnt lgkmcnt(11)
    v_mfma_f32_32x32x16_bf16 v[104:119], v[28:31], v[72:75], v[104:119]
    ds_read_b64_tr_b16 v[52:53], v14 offset:3328
    ds_read_b64_tr_b16 v[54:55], v14 offset:4096
    s_waitcnt lgkmcnt(11)
    v_mfma_f32_32x32x16_bf16 v[120:135], v[32:35], v[72:75], v[120:135]
    ds_read_b64_tr_b16 v[56:57], v14 offset:3584
    ds_read_b64_tr_b16 v[58:59], v14 offset:4352
    s_waitcnt lgkmcnt(11)
    v_mfma_f32_32x32x16_bf16 v[136:151], v[36:39], v[72:75], v[136:151]
    ds_read_b64_tr_b16 v[60:61], v14 offset:9216
    ds_read_b64_tr_b16 v[62:63], v14 offset:9984
    s_mov_b32 s8, 1144832
    s_add_u32 m0, s14, 20480
    s_nop 0
    buffer_load_dwordx4 v5, s[56:59], s8 offen lds
    s_waitcnt lgkmcnt(11)
    v_mfma_f32_32x32x16_bf16 v[152:167], v[40:43], v[72:75], v[152:167]
    ds_read_b64_tr_b16 v[64:65], v14 offset:9472
    ds_read_b64_tr_b16 v[66:67], v14 offset:10240
    s_mov_b32 s8, 1144832
    s_add_u32 m0, s14, 21504
    s_nop 0
    buffer_load_dwordx4 v6, s[56:59], s8 offen lds
    s_waitcnt lgkmcnt(11)
    v_mfma_f32_32x32x16_bf16 v[168:183], v[44:47], v[72:75], v[168:183]
    ds_read_b64_tr_b16 v[68:69], v14 offset:9728
    ds_read_b64_tr_b16 v[70:71], v14 offset:10496
    s_mov_b32 s8, 1144832
    s_add_u32 m0, s14, 22528
    s_nop 0
    buffer_load_dwordx4 v7, s[56:59], s8 offen lds
    s_waitcnt lgkmcnt(10)
    v_mfma_f32_32x32x16_bf16 v[88:103], v[48:51], v[76:79], v[88:103]
    s_mov_b32 s8, 832
    s_add_u32 m0, s15, 20480
    s_nop 0
    buffer_load_dwordx4 v8, s[48:51], s8 offen lds
    s_waitcnt lgkmcnt(8)
    v_mfma_f32_32x32x16_bf16 v[104:119], v[52:55], v[76:79], v[104:119]
    s_mov_b32 s8, 832
    s_add_u32 m0, s15, 21504
    s_nop 0
    buffer_load_dwordx4 v9, s[48:51], s8 offen lds
    s_waitcnt lgkmcnt(6)
    v_mfma_f32_32x32x16_bf16 v[120:135], v[56:59], v[76:79], v[120:135]
    s_waitcnt lgkmcnt(4)
    v_mfma_f32_32x32x16_bf16 v[136:151], v[60:63], v[76:79], v[136:151]
    s_waitcnt lgkmcnt(2)
    v_mfma_f32_32x32x16_bf16 v[152:167], v[64:67], v[76:79], v[152:167]
    s_waitcnt lgkmcnt(0)
    v_mfma_f32_32x32x16_bf16 v[168:183], v[68:71], v[76:79], v[168:183]
    s_waitcnt vmcnt(10)
    s_barrier
    ds_read_b128 v[72:75], v19 offset:20480
    ds_read_b64_tr_b16 v[24:25], v14 offset:20480
    ds_read_b64_tr_b16 v[26:27], v14 offset:21248
    ds_read_b64_tr_b16 v[28:29], v14 offset:20736
    ds_read_b64_tr_b16 v[30:31], v14 offset:21504
    ds_read_b64_tr_b16 v[32:33], v14 offset:20992
    ds_read_b64_tr_b16 v[34:35], v14 offset:21760
    ds_read_b64_tr_b16 v[36:37], v14 offset:26624
    ds_read_b64_tr_b16 v[38:39], v14 offset:27392
    ds_read_b64_tr_b16 v[40:41], v14 offset:26880
    ds_read_b64_tr_b16 v[42:43], v14 offset:27648
    ds_read_b64_tr_b16 v[44:45], v14 offset:27136
    ds_read_b64_tr_b16 v[46:47], v14 offset:27904
    s_waitcnt lgkmcnt(10)
    v_mfma_f32_32x32x16_bf16 v[88:103], v[24:27], v[72:75], v[88:103]
    ds_read_b128 v[76:79], v20 offset:20480
    ds_read_b64_tr_b16 v[48:49], v14 offset:23552
    ds_read_b64_tr_b16 v[50:51], v14 offset:24320
    s_waitcnt lgkmcnt(11)
    v_mfma_f32_32x32x16_bf16 v[104:119], v[28:31], v[72:75], v[104:119]
    ds_read_b64_tr_b16 v[52:53], v14 offset:23808
    ds_read_b64_tr_b16 v[54:55], v14 offset:24576
    s_waitcnt lgkmcnt(11)
    v_mfma_f32_32x32x16_bf16 v[120:135], v[32:35], v[72:75], v[120:135]
    ds_read_b64_tr_b16 v[56:57], v14 offset:24064
    ds_read_b64_tr_b16 v[58:59], v14 offset:24832
    s_waitcnt lgkmcnt(11)
    v_mfma_f32_32x32x16_bf16 v[136:151], v[36:39], v[72:75], v[136:151]
    ds_read_b64_tr_b16 v[60:61], v14 offset:29696
    ds_read_b64_tr_b16 v[62:63], v14 offset:30464
    s_mov_b32 s8, 1232896
    s_add_u32 m0, s14, 40960
    s_nop 0
    buffer_load_dwordx4 v5, s[56:59], s8 offen lds
    s_waitcnt lgkmcnt(11)
    v_mfma_f32_32x32x16_bf16 v[152:167], v[40:43], v[72:75], v[152:167]
    ds_read_b64_tr_b16 v[64:65], v14 offset:29952
    ds_read_b64_tr_b16 v[66:67], v14 offset:30720
    s_mov_b32 s8, 1232896
    s_add_u32 m0, s14, 41984
    s_nop 0
    buffer_load_dwordx4 v6, s[56:59], s8 offen lds
    s_waitcnt lgkmcnt(11)
    v_mfma_f32_32x32x16_bf16 v[168:183], v[44:47], v[72:75], v[168:183]
    ds_read_b64_tr_b16 v[68:69], v14 offset:30208
    ds_read_b64_tr_b16 v[70:71], v14 offset:30976
    s_mov_b32 s8, 1232896
    s_add_u32 m0, s14, 43008
    s_nop 0
    buffer_load_dwordx4 v7, s[56:59], s8 offen lds
    s_waitcnt lgkmcnt(10)
    v_mfma_f32_32x32x16_bf16 v[88:103], v[48:51], v[76:79], v[88:103]
    s_mov_b32 s8, 896
    s_add_u32 m0, s15, 40960
    s_nop 0
    buffer_load_dwordx4 v8, s[48:51], s8 offen lds
    s_waitcnt lgkmcnt(8)
    v_mfma_f32_32x32x16_bf16 v[104:119], v[52:55], v[76:79], v[104:119]
    s_mov_b32 s8, 896
    s_add_u32 m0, s15, 41984
    s_nop 0
    buffer_load_dwordx4 v9, s[48:51], s8 offen lds
    s_waitcnt lgkmcnt(6)
    v_mfma_f32_32x32x16_bf16 v[120:135], v[56:59], v[76:79], v[120:135]
    s_waitcnt lgkmcnt(4)
    v_mfma_f32_32x32x16_bf16 v[136:151], v[60:63], v[76:79], v[136:151]
    s_waitcnt lgkmcnt(2)
    v_mfma_f32_32x32x16_bf16 v[152:167], v[64:67], v[76:79], v[152:167]
    s_waitcnt lgkmcnt(0)
    v_mfma_f32_32x32x16_bf16 v[168:183], v[68:71], v[76:79], v[168:183]
    s_waitcnt vmcnt(10)
    s_barrier
    ds_read_b128 v[72:75], v17 offset:0
    ds_read_b64_tr_b16 v[24:25], v13 offset:0
    ds_read_b64_tr_b16 v[26:27], v13 offset:768
    ds_read_b64_tr_b16 v[28:29], v13 offset:256
    ds_read_b64_tr_b16 v[30:31], v13 offset:1024
    ds_read_b64_tr_b16 v[32:33], v13 offset:512
    ds_read_b64_tr_b16 v[34:35], v13 offset:1280
    ds_read_b64_tr_b16 v[36:37], v13 offset:6144
    ds_read_b64_tr_b16 v[38:39], v13 offset:6912
    ds_read_b64_tr_b16 v[40:41], v13 offset:6400
    ds_read_b64_tr_b16 v[42:43], v13 offset:7168
    ds_read_b64_tr_b16 v[44:45], v13 offset:6656
    ds_read_b64_tr_b16 v[46:47], v13 offset:7424
    s_waitcnt lgkmcnt(10)
    v_mfma_f32_32x32x16_bf16 v[88:103], v[24:27], v[72:75], v[88:103]
    ds_read_b128 v[76:79], v18 offset:0
    ds_read_b64_tr_b16 v[48:49], v13 offset:3072
    ds_read_b64_tr_b16 v[50:51], v13 offset:3840
    s_waitcnt lgkmcnt(11)
    v_mfma_f32_32x32x16_bf16 v[104:119], v[28:31], v[72:75], v[104:119]
    ds_read_b64_tr_b16 v[52:53], v13 offset:3328
    ds_read_b64_tr_b16 v[54:55], v13 offset:4096
    s_waitcnt lgkmcnt(11)
    v_mfma_f32_32x32x16_bf16 v[120:135], v[32:35], v[72:75], v[120:135]
    ds_read_b64_tr_b16 v[56:57], v13 offset:3584
    ds_read_b64_tr_b16 v[58:59], v13 offset:4352
    s_waitcnt lgkmcnt(11)
    v_mfma_f32_32x32x16_bf16 v[136:151], v[36:39], v[72:75], v[136:151]
    ds_read_b64_tr_b16 v[60:61], v13 offset:9216
    ds_read_b64_tr_b16 v[62:63], v13 offset:9984
    s_mov_b32 s8, 1320960
    s_add_u32 m0, s14, 61440
    s_nop 0
    buffer_load_dwordx4 v5, s[56:59], s8 offen lds
    s_waitcnt lgkmcnt(11)
    v_mfma_f32_32x32x16_bf16 v[152:167], v[40:43], v[72:75], v[152:167]
    ds_read_b64_tr_b16 v[64:65], v13 offset:9472
    ds_read_b64_tr_b16 v[66:67], v13 offset:10240
    s_mov_b32 s8, 1320960
    s_add_u32 m0, s14, 62464
    s_nop 0
    buffer_load_dwordx4 v6, s[56:59], s8 offen lds
    s_waitcnt lgkmcnt(11)
    v_mfma_f32_32x32x16_bf16 v[168:183], v[44:47], v[72:75], v[168:183]
    ds_read_b64_tr_b16 v[68:69], v13 offset:9728
    ds_read_b64_tr_b16 v[70:71], v13 offset:10496
    s_mov_b32 s8, 1320960
    s_add_u32 m0, s14, 63488
    s_nop 0
    buffer_load_dwordx4 v7, s[56:59], s8 offen lds
    s_waitcnt lgkmcnt(10)
    v_mfma_f32_32x32x16_bf16 v[88:103], v[48:51], v[76:79], v[88:103]
    s_mov_b32 s8, 960
    s_add_u32 m0, s15, 61440
    s_nop 0
    buffer_load_dwordx4 v8, s[48:51], s8 offen lds
    s_waitcnt lgkmcnt(8)
    v_mfma_f32_32x32x16_bf16 v[104:119], v[52:55], v[76:79], v[104:119]
    s_mov_b32 s8, 960
    s_add_u32 m0, s15, 62464
    s_nop 0
    buffer_load_dwordx4 v9, s[48:51], s8 offen lds
    s_waitcnt lgkmcnt(6)
    v_mfma_f32_32x32x16_bf16 v[120:135], v[56:59], v[76:79], v[120:135]
    s_waitcnt lgkmcnt(4)
    v_mfma_f32_32x32x16_bf16 v[136:151], v[60:63], v[76:79], v[136:151]
    s_waitcnt lgkmcnt(2)
    v_mfma_f32_32x32x16_bf16 v[152:167], v[64:67], v[76:79], v[152:167]
    s_waitcnt lgkmcnt(0)
    v_mfma_f32_32x32x16_bf16 v[168:183], v[68:71], v[76:79], v[168:183]
    s_waitcnt vmcnt(10)
    s_barrier
    ds_read_b128 v[72:75], v17 offset:20480
    ds_read_b64_tr_b16 v[24:25], v13 offset:20480
    ds_read_b64_tr_b16 v[26:27], v13 offset:21248
    ds_read_b64_tr_b16 v[28:29], v13 offset:20736
    ds_read_b64_tr_b16 v[30:31], v13 offset:21504
    ds_read_b64_tr_b16 v[32:33], v13 offset:20992
    ds_read_b64_tr_b16 v[34:35], v13 offset:21760
    ds_read_b64_tr_b16 v[36:37], v13 offset:26624
    ds_read_b64_tr_b16 v[38:39], v13 offset:27392
    ds_read_b64_tr_b16 v[40:41], v13 offset:26880
    ds_read_b64_tr_b16 v[42:43], v13 offset:27648
    ds_read_b64_tr_b16 v[44:45], v13 offset:27136
    ds_read_b64_tr_b16 v[46:47], v13 offset:27904
    s_waitcnt lgkmcnt(10)
    v_mfma_f32_32x32x16_bf16 v[88:103], v[24:27], v[72:75], v[88:103]
    ds_read_b128 v[76:79], v18 offset:20480
    ds_read_b64_tr_b16 v[48:49], v13 offset:23552
    ds_read_b64_tr_b16 v[50:51], v13 offset:24320
    s_waitcnt lgkmcnt(11)
    v_mfma_f32_32x32x16_bf16 v[104:119], v[28:31], v[72:75], v[104:119]
    ds_read_b64_tr_b16 v[52:53], v13 offset:23808
    ds_read_b64_tr_b16 v[54:55], v13 offset:24576
    s_waitcnt lgkmcnt(11)
    v_mfma_f32_32x32x16_bf16 v[120:135], v[32:35], v[72:75], v[120:135]
    ds_read_b64_tr_b16 v[56:57], v13 offset:24064
    ds_read_b64_tr_b16 v[58:59], v13 offset:24832
    s_waitcnt lgkmcnt(11)
    v_mfma_f32_32x32x16_bf16 v[136:151], v[36:39], v[72:75], v[136:151]
    ds_read_b64_tr_b16 v[60:61], v13 offset:29696
    ds_read_b64_tr_b16 v[62:63], v13 offset:30464
    s_waitcnt lgkmcnt(11)
    v_mfma_f32_32x32x16_bf16 v[152:167], v[40:43], v[72:75], v[152:167]
    ds_read_b64_tr_b16 v[64:65], v13 offset:29952
    ds_read_b64_tr_b16 v[66:67], v13 offset:30720
    s_waitcnt lgkmcnt(11)
    v_mfma_f32_32x32x16_bf16 v[168:183], v[44:47], v[72:75], v[168:183]
    ds_read_b64_tr_b16 v[68:69], v13 offset:30208
    ds_read_b64_tr_b16 v[70:71], v13 offset:30976
    s_waitcnt lgkmcnt(10)
    v_mfma_f32_32x32x16_bf16 v[88:103], v[48:51], v[76:79], v[88:103]
    s_waitcnt lgkmcnt(8)
    v_mfma_f32_32x32x16_bf16 v[104:119], v[52:55], v[76:79], v[104:119]
    s_waitcnt lgkmcnt(6)
    v_mfma_f32_32x32x16_bf16 v[120:135], v[56:59], v[76:79], v[120:135]
    s_waitcnt lgkmcnt(4)
    v_mfma_f32_32x32x16_bf16 v[136:151], v[60:63], v[76:79], v[136:151]
    s_waitcnt lgkmcnt(2)
    v_mfma_f32_32x32x16_bf16 v[152:167], v[64:67], v[76:79], v[152:167]
    s_waitcnt lgkmcnt(0)
    v_mfma_f32_32x32x16_bf16 v[168:183], v[68:71], v[76:79], v[168:183]
    s_waitcnt vmcnt(5)
    s_barrier
    ds_read_b128 v[72:75], v19 offset:0
    ds_read_b64_tr_b16 v[24:25], v14 offset:0
    ds_read_b64_tr_b16 v[26:27], v14 offset:768
    ds_read_b64_tr_b16 v[28:29], v14 offset:256
    ds_read_b64_tr_b16 v[30:31], v14 offset:1024
    ds_read_b64_tr_b16 v[32:33], v14 offset:512
    ds_read_b64_tr_b16 v[34:35], v14 offset:1280
    ds_read_b64_tr_b16 v[36:37], v14 offset:6144
    ds_read_b64_tr_b16 v[38:39], v14 offset:6912
    ds_read_b64_tr_b16 v[40:41], v14 offset:6400
    ds_read_b64_tr_b16 v[42:43], v14 offset:7168
    ds_read_b64_tr_b16 v[44:45], v14 offset:6656
    ds_read_b64_tr_b16 v[46:47], v14 offset:7424
    s_waitcnt lgkmcnt(10)
    v_mfma_f32_32x32x16_bf16 v[88:103], v[24:27], v[72:75], v[88:103]
    ds_read_b128 v[76:79], v20 offset:0
    ds_read_b64_tr_b16 v[48:49], v14 offset:3072
    ds_read_b64_tr_b16 v[50:51], v14 offset:3840
    s_waitcnt lgkmcnt(11)
    v_mfma_f32_32x32x16_bf16 v[104:119], v[28:31], v[72:75], v[104:119]
    ds_read_b64_tr_b16 v[52:53], v14 offset:3328
    ds_read_b64_tr_b16 v[54:55], v14 offset:4096
    s_waitcnt lgkmcnt(11)
    v_mfma_f32_32x32x16_bf16 v[120:135], v[32:35], v[72:75], v[120:135]
    ds_read_b64_tr_b16 v[56:57], v14 offset:3584
    ds_read_b64_tr_b16 v[58:59], v14 offset:4352
    s_waitcnt lgkmcnt(11)
    v_mfma_f32_32x32x16_bf16 v[136:151], v[36:39], v[72:75], v[136:151]
    ds_read_b64_tr_b16 v[60:61], v14 offset:9216
    ds_read_b64_tr_b16 v[62:63], v14 offset:9984
    s_waitcnt lgkmcnt(11)
    v_mfma_f32_32x32x16_bf16 v[152:167], v[40:43], v[72:75], v[152:167]
    ds_read_b64_tr_b16 v[64:65], v14 offset:9472
    ds_read_b64_tr_b16 v[66:67], v14 offset:10240
    s_waitcnt lgkmcnt(11)
    v_mfma_f32_32x32x16_bf16 v[168:183], v[44:47], v[72:75], v[168:183]
    ds_read_b64_tr_b16 v[68:69], v14 offset:9728
    ds_read_b64_tr_b16 v[70:71], v14 offset:10496
    s_waitcnt lgkmcnt(10)
    v_mfma_f32_32x32x16_bf16 v[88:103], v[48:51], v[76:79], v[88:103]
    s_waitcnt lgkmcnt(8)
    v_mfma_f32_32x32x16_bf16 v[104:119], v[52:55], v[76:79], v[104:119]
    s_waitcnt lgkmcnt(6)
    v_mfma_f32_32x32x16_bf16 v[120:135], v[56:59], v[76:79], v[120:135]
    s_waitcnt lgkmcnt(4)
    v_mfma_f32_32x32x16_bf16 v[136:151], v[60:63], v[76:79], v[136:151]
    s_waitcnt lgkmcnt(2)
    v_mfma_f32_32x32x16_bf16 v[152:167], v[64:67], v[76:79], v[152:167]
    s_waitcnt lgkmcnt(0)
    v_mfma_f32_32x32x16_bf16 v[168:183], v[68:71], v[76:79], v[168:183]
    s_waitcnt vmcnt(0)
    s_barrier
    ds_read_b128 v[72:75], v19 offset:20480
    ds_read_b64_tr_b16 v[24:25], v14 offset:20480
    ds_read_b64_tr_b16 v[26:27], v14 offset:21248
    ds_read_b64_tr_b16 v[28:29], v14 offset:20736
    ds_read_b64_tr_b16 v[30:31], v14 offset:21504
    ds_read_b64_tr_b16 v[32:33], v14 offset:20992
    ds_read_b64_tr_b16 v[34:35], v14 offset:21760
    ds_read_b64_tr_b16 v[36:37], v14 offset:26624
    ds_read_b64_tr_b16 v[38:39], v14 offset:27392
    ds_read_b64_tr_b16 v[40:41], v14 offset:26880
    ds_read_b64_tr_b16 v[42:43], v14 offset:27648
    ds_read_b64_tr_b16 v[44:45], v14 offset:27136
    ds_read_b64_tr_b16 v[46:47], v14 offset:27904
    s_waitcnt lgkmcnt(10)
    v_mfma_f32_32x32x16_bf16 v[88:103], v[24:27], v[72:75], v[88:103]
    ds_read_b128 v[76:79], v20 offset:20480
    ds_read_b64_tr_b16 v[48:49], v14 offset:23552
    ds_read_b64_tr_b16 v[50:51], v14 offset:24320
    s_waitcnt lgkmcnt(11)
    v_mfma_f32_32x32x16_bf16 v[104:119], v[28:31], v[72:75], v[104:119]
    ds_read_b64_tr_b16 v[52:53], v14 offset:23808
    ds_read_b64_tr_b16 v[54:55], v14 offset:24576
    s_waitcnt lgkmcnt(11)
    v_mfma_f32_32x32x16_bf16 v[120:135], v[32:35], v[72:75], v[120:135]
    ds_read_b64_tr_b16 v[56:57], v14 offset:24064
    ds_read_b64_tr_b16 v[58:59], v14 offset:24832
    s_waitcnt lgkmcnt(11)
    v_mfma_f32_32x32x16_bf16 v[136:151], v[36:39], v[72:75], v[136:151]
    ds_read_b64_tr_b16 v[60:61], v14 offset:29696
    ds_read_b64_tr_b16 v[62:63], v14 offset:30464
    s_waitcnt lgkmcnt(11)
    v_mfma_f32_32x32x16_bf16 v[152:167], v[40:43], v[72:75], v[152:167]
    ds_read_b64_tr_b16 v[64:65], v14 offset:29952
    ds_read_b64_tr_b16 v[66:67], v14 offset:30720
    s_waitcnt lgkmcnt(11)
    v_mfma_f32_32x32x16_bf16 v[168:183], v[44:47], v[72:75], v[168:183]
    ds_read_b64_tr_b16 v[68:69], v14 offset:30208
    ds_read_b64_tr_b16 v[70:71], v14 offset:30976
    s_waitcnt lgkmcnt(10)
    v_mfma_f32_32x32x16_bf16 v[88:103], v[48:51], v[76:79], v[88:103]
    s_waitcnt lgkmcnt(8)
    v_mfma_f32_32x32x16_bf16 v[104:119], v[52:55], v[76:79], v[104:119]
    s_waitcnt lgkmcnt(6)
    v_mfma_f32_32x32x16_bf16 v[120:135], v[56:59], v[76:79], v[120:135]
    s_waitcnt lgkmcnt(4)
    v_mfma_f32_32x32x16_bf16 v[136:151], v[60:63], v[76:79], v[136:151]
    s_waitcnt lgkmcnt(2)
    v_mfma_f32_32x32x16_bf16 v[152:167], v[64:67], v[76:79], v[152:167]
    s_waitcnt lgkmcnt(0)
    v_mfma_f32_32x32x16_bf16 v[168:183], v[68:71], v[76:79], v[168:183]
    s_setprio 0
    v_mov_b32 v16, 0xc0135761
    v_mov_b32 v17, 0xc0135761
    v_mov_b32 v18, 0xbdd2d3e8
    v_mov_b32 v19, 0xbdd2d3e8
    v_mov_b32 v20, 1.0
    v_mov_b32 v21, 1.0
    s_lshl_b32 s8, s4, 2
    s_add_u32 s8, s8, s7
    s_mul_i32 s8, s8, 172
    s_mul_i32 s9, s5, 12
    s_add_u32 s8, s8, s9
    s_lshl_b32 s8, s8, 9
    v_lshlrev_b32 v5, 4, v2
    v_lshl_add_u32 v5, v3, 3, v5
    v_add_u32 v5, s8, v5
    v_add_u32 v6, 0x1000, v5
    v_cvt_pk_bf16_f32 v26, 0, v88
    v_cvt_pk_bf16_f32 v38, 0, v90
    v_cvt_pk_bf16_f32 v27, 0, v89
    v_cvt_pk_bf16_f32 v39, 0, v91
    v_cvt_pk_bf16_f32 v28, 0, v136
    v_cvt_pk_bf16_f32 v40, 0, v138
    v_cvt_pk_bf16_f32 v29, 0, v137
    v_cvt_pk_bf16_f32 v41, 0, v139
    v_mul_f32 v30, v26, v26
    v_mul_f32 v42, v38, v38
    v_mul_f32 v31, v27, v27
    v_mul_f32 v43, v39, v39
    v_fma_f32 v30, v30, v18, v16
    v_fma_f32 v42, v42, v18, v16
    v_fma_f32 v31, v31, v18, v16
    v_fma_f32 v43, v43, v18, v16
    v_mul_f32 v30, v30, v26
    v_mul_f32 v42, v42, v38
    v_mul_f32 v31, v31, v27
    v_mul_f32 v43, v43, v39
    v_exp_f32 v30, v30
    v_exp_f32 v42, v42
    v_exp_f32 v31, v31
    v_exp_f32 v43, v43
    v_add_f32 v30, 1.0, v30
    v_add_f32 v42, 1.0, v42
    v_add_f32 v31, 1.0, v31
    v_add_f32 v43, 1.0, v43
    v_rcp_f32 v30, v30
    v_rcp_f32 v42, v42
    v_rcp_f32 v31, v31
    v_rcp_f32 v43, v43
    v_mul_f32 v30, v30, v26
    v_mul_f32 v42, v42, v38
    v_mul_f32 v31, v31, v27
    v_mul_f32 v43, v43, v39
    v_cvt_pk_bf16_f32 v32, 0, v30
    v_cvt_pk_bf16_f32 v44, 0, v42
    v_cvt_pk_bf16_f32 v33, 0, v31
    v_cvt_pk_bf16_f32 v45, 0, v43
    v_mul_f32 v32, v32, v28
    v_mul_f32 v44, v44, v40
    v_mul_f32 v33, v33, v29
    v_mul_f32 v45, v45, v41
    v_cvt_pk_bf16_f32 v64, v32, v33
    v_cvt_pk_bf16_f32 v65, v44, v45
    buffer_store_dwordx2 v[64:65], v5, s[52:55], 0 offen offset:0
    v_cvt_pk_bf16_f32 v26, 0, v92
    v_cvt_pk_bf16_f32 v38, 0, v94
    v_cvt_pk_bf16_f32 v27, 0, v93
    v_cvt_pk_bf16_f32 v39, 0, v95
    v_cvt_pk_bf16_f32 v28, 0, v140
    v_cvt_pk_bf16_f32 v40, 0, v142
    v_cvt_pk_bf16_f32 v29, 0, v141
    v_cvt_pk_bf16_f32 v41, 0, v143
    v_mul_f32 v30, v26, v26
    v_mul_f32 v42, v38, v38
    v_mul_f32 v31, v27, v27
    v_mul_f32 v43, v39, v39
    v_fma_f32 v30, v30, v18, v16
    v_fma_f32 v42, v42, v18, v16
    v_fma_f32 v31, v31, v18, v16
    v_fma_f32 v43, v43, v18, v16
    v_mul_f32 v30, v30, v26
    v_mul_f32 v42, v42, v38
    v_mul_f32 v31, v31, v27
    v_mul_f32 v43, v43, v39
    v_exp_f32 v30, v30
    v_exp_f32 v42, v42
    v_exp_f32 v31, v31
    v_exp_f32 v43, v43
    v_add_f32 v30, 1.0, v30
    v_add_f32 v42, 1.0, v42
    v_add_f32 v31, 1.0, v31
    v_add_f32 v43, 1.0, v43
    v_rcp_f32 v30, v30
    v_rcp_f32 v42, v42
    v_rcp_f32 v31, v31
    v_rcp_f32 v43, v43
    v_mul_f32 v30, v30, v26
    v_mul_f32 v42, v42, v38
    v_mul_f32 v31, v31, v27
    v_mul_f32 v43, v43, v39
    v_cvt_pk_bf16_f32 v32, 0, v30
    v_cvt_pk_bf16_f32 v44, 0, v42
    v_cvt_pk_bf16_f32 v33, 0, v31
    v_cvt_pk_bf16_f32 v45, 0, v43
    v_mul_f32 v32, v32, v28
    v_mul_f32 v44, v44, v40
    v_mul_f32 v33, v33, v29
    v_mul_f32 v45, v45, v41
    v_cvt_pk_bf16_f32 v66, v32, v33
    v_cvt_pk_bf16_f32 v67, v44, v45
    buffer_store_dwordx2 v[66:67], v5, s[52:55], 0 offen offset:512
    v_cvt_pk_bf16_f32 v26, 0, v96
    v_cvt_pk_bf16_f32 v38, 0, v98
    v_cvt_pk_bf16_f32 v27, 0, v97
    v_cvt_pk_bf16_f32 v39, 0, v99
    v_cvt_pk_bf16_f32 v28, 0, v144
    v_cvt_pk_bf16_f32 v40, 0, v146
    v_cvt_pk_bf16_f32 v29, 0, v145
    v_cvt_pk_bf16_f32 v41, 0, v147
    v_mul_f32 v30, v26, v26
    v_mul_f32 v42, v38, v38
    v_mul_f32 v31, v27, v27
    v_mul_f32 v43, v39, v39
    v_fma_f32 v30, v30, v18, v16
    v_fma_f32 v42, v42, v18, v16
    v_fma_f32 v31, v31, v18, v16
    v_fma_f32 v43, v43, v18, v16
    v_mul_f32 v30, v30, v26
    v_mul_f32 v42, v42, v38
    v_mul_f32 v31, v31, v27
    v_mul_f32 v43, v43, v39
    v_exp_f32 v30, v30
    v_exp_f32 v42, v42
    v_exp_f32 v31, v31
    v_exp_f32 v43, v43
    v_add_f32 v30, 1.0, v30
    v_add_f32 v42, 1.0, v42
    v_add_f32 v31, 1.0, v31
    v_add_f32 v43, 1.0, v43
    v_rcp_f32 v30, v30
    v_rcp_f32 v42, v42
    v_rcp_f32 v31, v31
    v_rcp_f32 v43, v43
    v_mul_f32 v30, v30, v26
    v_mul_f32 v42, v42, v38
    v_mul_f32 v31, v31, v27
    v_mul_f32 v43, v43, v39
    v_cvt_pk_bf16_f32 v32, 0, v30
    v_cvt_pk_bf16_f32 v44, 0, v42
    v_cvt_pk_bf16_f32 v33, 0, v31
    v_cvt_pk_bf16_f32 v45, 0, v43
    v_mul_f32 v32, v32, v28
    v_mul_f32 v44, v44, v40
    v_mul_f32 v33, v33, v29
    v_mul_f32 v45, v45, v41
    v_cvt_pk_bf16_f32 v64, v32, v33
    v_cvt_pk_bf16_f32 v65, v44, v45
    buffer_store_dwordx2 v[64:65], v5, s[52:55], 0 offen offset:1024
    v_cvt_pk_bf16_f32 v26, 0, v100
    v_cvt_pk_bf16_f32 v38, 0, v102
    v_cvt_pk_bf16_f32 v27, 0, v101
    v_cvt_pk_bf16_f32 v39, 0, v103
    v_cvt_pk_bf16_f32 v28, 0, v148
    v_cvt_pk_bf16_f32 v40, 0, v150
    v_cvt_pk_bf16_f32 v29, 0, v149
    v_cvt_pk_bf16_f32 v41, 0, v151
    v_mul_f32 v30, v26, v26
    v_mul_f32 v42, v38, v38
    v_mul_f32 v31, v27, v27
    v_mul_f32 v43, v39, v39
    v_fma_f32 v30, v30, v18, v16
    v_fma_f32 v42, v42, v18, v16
    v_fma_f32 v31, v31, v18, v16
    v_fma_f32 v43, v43, v18, v16
    v_mul_f32 v30, v30, v26
    v_mul_f32 v42, v42, v38
    v_mul_f32 v31, v31, v27
    v_mul_f32 v43, v43, v39
    v_exp_f32 v30, v30
    v_exp_f32 v42, v42
    v_exp_f32 v31, v31
    v_exp_f32 v43, v43
    v_add_f32 v30, 1.0, v30
    v_add_f32 v42, 1.0, v42
    v_add_f32 v31, 1.0, v31
    v_add_f32 v43, 1.0, v43
    v_rcp_f32 v30, v30
    v_rcp_f32 v42, v42
    v_rcp_f32 v31, v31
    v_rcp_f32 v43, v43
    v_mul_f32 v30, v30, v26
    v_mul_f32 v42, v42, v38
    v_mul_f32 v31, v31, v27
    v_mul_f32 v43, v43, v39
    v_cvt_pk_bf16_f32 v32, 0, v30
    v_cvt_pk_bf16_f32 v44, 0, v42
    v_cvt_pk_bf16_f32 v33, 0, v31
    v_cvt_pk_bf16_f32 v45, 0, v43
    v_mul_f32 v32, v32, v28
    v_mul_f32 v44, v44, v40
    v_mul_f32 v33, v33, v29
    v_mul_f32 v45, v45, v41
    v_cvt_pk_bf16_f32 v66, v32, v33
    v_cvt_pk_bf16_f32 v67, v44, v45
    buffer_store_dwordx2 v[66:67], v5, s[52:55], 0 offen offset:1536
    s_cmp_eq_u32 s5, 14
    s_cbranch_scc1 L_g1_done
    v_cvt_pk_bf16_f32 v26, 0, v104
    v_cvt_pk_bf16_f32 v38, 0, v106
    v_cvt_pk_bf16_f32 v27, 0, v105
    v_cvt_pk_bf16_f32 v39, 0, v107
    v_cvt_pk_bf16_f32 v28, 0, v152
    v_cvt_pk_bf16_f32 v40, 0, v154
    v_cvt_pk_bf16_f32 v29, 0, v153
    v_cvt_pk_bf16_f32 v41, 0, v155
    v_mul_f32 v30, v26, v26
    v_mul_f32 v42, v38, v38
    v_mul_f32 v31, v27, v27
    v_mul_f32 v43, v39, v39
    v_fma_f32 v30, v30, v18, v16
    v_fma_f32 v42, v42, v18, v16
    v_fma_f32 v31, v31, v18, v16
    v_fma_f32 v43, v43, v18, v16
    v_mul_f32 v30, v30, v26
    v_mul_f32 v42, v42, v38
    v_mul_f32 v31, v31, v27
    v_mul_f32 v43, v43, v39
    v_exp_f32 v30, v30
    v_exp_f32 v42, v42
    v_exp_f32 v31, v31
    v_exp_f32 v43, v43
    v_add_f32 v30, 1.0, v30
    v_add_f32 v42, 1.0, v42
    v_add_f32 v31, 1.0, v31
    v_add_f32 v43, 1.0, v43
    v_rcp_f32 v30, v30
    v_rcp_f32 v42, v42
    v_rcp_f32 v31, v31
    v_rcp_f32 v43, v43
    v_mul_f32 v30, v30, v26
    v_mul_f32 v42, v42, v38
    v_mul_f32 v31, v31, v27
    v_mul_f32 v43, v43, v39
    v_cvt_pk_bf16_f32 v32, 0, v30
    v_cvt_pk_bf16_f32 v44, 0, v42
    v_cvt_pk_bf16_f32 v33, 0, v31
    v_cvt_pk_bf16_f32 v45, 0, v43
    v_mul_f32 v32, v32, v28
    v_mul_f32 v44, v44, v40
    v_mul_f32 v33, v33, v29
    v_mul_f32 v45, v45, v41
    v_cvt_pk_bf16_f32 v64, v32, v33
    v_cvt_pk_bf16_f32 v65, v44, v45
    buffer_store_dwordx2 v[64:65], v5, s[52:55], 0 offen offset:2048
    v_cvt_pk_bf16_f32 v26, 0, v108
    v_cvt_pk_bf16_f32 v38, 0, v110
    v_cvt_pk_bf16_f32 v27, 0, v109
    v_cvt_pk_bf16_f32 v39, 0, v111
    v_cvt_pk_bf16_f32 v28, 0, v156
    v_cvt_pk_bf16_f32 v40, 0, v158
    v_cvt_pk_bf16_f32 v29, 0, v157
    v_cvt_pk_bf16_f32 v41, 0, v159
    v_mul_f32 v30, v26, v26
    v_mul_f32 v42, v38, v38
    v_mul_f32 v31, v27, v27
    v_mul_f32 v43, v39, v39
    v_fma_f32 v30, v30, v18, v16
    v_fma_f32 v42, v42, v18, v16
    v_fma_f32 v31, v31, v18, v16
    v_fma_f32 v43, v43, v18, v16
    v_mul_f32 v30, v30, v26
    v_mul_f32 v42, v42, v38
    v_mul_f32 v31, v31, v27
    v_mul_f32 v43, v43, v39
    v_exp_f32 v30, v30
    v_exp_f32 v42, v42
    v_exp_f32 v31, v31
    v_exp_f32 v43, v43
    v_add_f32 v30, 1.0, v30
    v_add_f32 v42, 1.0, v42
    v_add_f32 v31, 1.0, v31
    v_add_f32 v43, 1.0, v43
    v_rcp_f32 v30, v30
    v_rcp_f32 v42, v42
    v_rcp_f32 v31, v31
    v_rcp_f32 v43, v43
    v_mul_f32 v30, v30, v26
    v_mul_f32 v42, v42, v38
    v_mul_f32 v31, v31, v27
    v_mul_f32 v43, v43, v39
    v_cvt_pk_bf16_f32 v32, 0, v30
    v_cvt_pk_bf16_f32 v44, 0, v42
    v_cvt_pk_bf16_f32 v33, 0, v31
    v_cvt_pk_bf16_f32 v45, 0, v43
    v_mul_f32 v32, v32, v28
    v_mul_f32 v44, v44, v40
    v_mul_f32 v33, v33, v29
    v_mul_f32 v45, v45, v41
    v_cvt_pk_bf16_f32 v66, v32, v33
    v_cvt_pk_bf16_f32 v67, v44, v45
    buffer_store_dwordx2 v[66:67], v5, s[52:55], 0 offen offset:2560
    v_cvt_pk_bf16_f32 v26, 0, v112
    v_cvt_pk_bf16_f32 v38, 0, v114
    v_cvt_pk_bf16_f32 v27, 0, v113
    v_cvt_pk_bf16_f32 v39, 0, v115
    v_cvt_pk_bf16_f32 v28, 0, v160
    v_cvt_pk_bf16_f32 v40, 0, v162
    v_cvt_pk_bf16_f32 v29, 0, v161
    v_cvt_pk_bf16_f32 v41, 0, v163
    v_mul_f32 v30, v26, v26
    v_mul_f32 v42, v38, v38
    v_mul_f32 v31, v27, v27
    v_mul_f32 v43, v39, v39
    v_fma_f32 v30, v30, v18, v16
    v_fma_f32 v42, v42, v18, v16
    v_fma_f32 v31, v31, v18, v16
    v_fma_f32 v43, v43, v18, v16
    v_mul_f32 v30, v30, v26
    v_mul_f32 v42, v42, v38
    v_mul_f32 v31, v31, v27
    v_mul_f32 v43, v43, v39
    v_exp_f32 v30, v30
    v_exp_f32 v42, v42
    v_exp_f32 v31, v31
    v_exp_f32 v43, v43
    v_add_f32 v30, 1.0, v30
    v_add_f32 v42, 1.0, v42
    v_add_f32 v31, 1.0, v31
    v_add_f32 v43, 1.0, v43
    v_rcp_f32 v30, v30
    v_rcp_f32 v42, v42
    v_rcp_f32 v31, v31
    v_rcp_f32 v43, v43
    v_mul_f32 v30, v30, v26
    v_mul_f32 v42, v42, v38
    v_mul_f32 v31, v31, v27
    v_mul_f32 v43, v43, v39
    v_cvt_pk_bf16_f32 v32, 0, v30
    v_cvt_pk_bf16_f32 v44, 0, v42
    v_cvt_pk_bf16_f32 v33, 0, v31
    v_cvt_pk_bf16_f32 v45, 0, v43
    v_mul_f32 v32, v32, v28
    v_mul_f32 v44, v44, v40
    v_mul_f32 v33, v33, v29
    v_mul_f32 v45, v45, v41
    v_cvt_pk_bf16_f32 v64, v32, v33
    v_cvt_pk_bf16_f32 v65, v44, v45
    buffer_store_dwordx2 v[64:65], v5, s[52:55], 0 offen offset:3072
    v_cvt_pk_bf16_f32 v26, 0, v116
    v_cvt_pk_bf16_f32 v38, 0, v118
    v_cvt_pk_bf16_f32 v27, 0, v117
    v_cvt_pk_bf16_f32 v39, 0, v119
    v_cvt_pk_bf16_f32 v28, 0, v164
    v_cvt_pk_bf16_f32 v40, 0, v166
    v_cvt_pk_bf16_f32 v29, 0, v165
    v_cvt_pk_bf16_f32 v41, 0, v167
    v_mul_f32 v30, v26, v26
    v_mul_f32 v42, v38, v38
    v_mul_f32 v31, v27, v27
    v_mul_f32 v43, v39, v39
    v_fma_f32 v30, v30, v18, v16
    v_fma_f32 v42, v42, v18, v16
    v_fma_f32 v31, v31, v18, v16
    v_fma_f32 v43, v43, v18, v16
    v_mul_f32 v30, v30, v26
    v_mul_f32 v42, v42, v38
    v_mul_f32 v31, v31, v27
    v_mul_f32 v43, v43, v39
    v_exp_f32 v30, v30
    v_exp_f32 v42, v42
    v_exp_f32 v31, v31
    v_exp_f32 v43, v43
    v_add_f32 v30, 1.0, v30
    v_add_f32 v42, 1.0, v42
    v_add_f32 v31, 1.0, v31
    v_add_f32 v43, 1.0, v43
    v_rcp_f32 v30, v30
    v_rcp_f32 v42, v42
    v_rcp_f32 v31, v31
    v_rcp_f32 v43, v43
    v_mul_f32 v30, v30, v26
    v_mul_f32 v42, v42, v38
    v_mul_f32 v31, v31, v27
    v_mul_f32 v43, v43, v39
    v_cvt_pk_bf16_f32 v32, 0, v30
    v_cvt_pk_bf16_f32 v44, 0, v42
    v_cvt_pk_bf16_f32 v33, 0, v31
    v_cvt_pk_bf16_f32 v45, 0, v43
    v_mul_f32 v32, v32, v28
    v_mul_f32 v44, v44, v40
    v_mul_f32 v33, v33, v29
    v_mul_f32 v45, v45, v41
    v_cvt_pk_bf16_f32 v66, v32, v33
    v_cvt_pk_bf16_f32 v67, v44, v45
    buffer_store_dwordx2 v[66:67], v5, s[52:55], 0 offen offset:3584
    v_cvt_pk_bf16_f32 v26, 0, v120
    v_cvt_pk_bf16_f32 v38, 0, v122
    v_cvt_pk_bf16_f32 v27, 0, v121
    v_cvt_pk_bf16_f32 v39, 0, v123
    v_cvt_pk_bf16_f32 v28, 0, v168
    v_cvt_pk_bf16_f32 v40, 0, v170
    v_cvt_pk_bf16_f32 v29, 0, v169
    v_cvt_pk_bf16_f32 v41, 0, v171
    v_mul_f32 v30, v26, v26
    v_mul_f32 v42, v38, v38
    v_mul_f32 v31, v27, v27
    v_mul_f32 v43, v39, v39
    v_fma_f32 v30, v30, v18, v16
    v_fma_f32 v42, v42, v18, v16
    v_fma_f32 v31, v31, v18, v16
    v_fma_f32 v43, v43, v18, v16
    v_mul_f32 v30, v30, v26
    v_mul_f32 v42, v42, v38
    v_mul_f32 v31, v31, v27
    v_mul_f32 v43, v43, v39
    v_exp_f32 v30, v30
    v_exp_f32 v42, v42
    v_exp_f32 v31, v31
    v_exp_f32 v43, v43
    v_add_f32 v30, 1.0, v30
    v_add_f32 v42, 1.0, v42
    v_add_f32 v31, 1.0, v31
    v_add_f32 v43, 1.0, v43
    v_rcp_f32 v30, v30
    v_rcp_f32 v42, v42
    v_rcp_f32 v31, v31
    v_rcp_f32 v43, v43
    v_mul_f32 v30, v30, v26
    v_mul_f32 v42, v42, v38
    v_mul_f32 v31, v31, v27
    v_mul_f32 v43, v43, v39
    v_cvt_pk_bf16_f32 v32, 0, v30
    v_cvt_pk_bf16_f32 v44, 0, v42
    v_cvt_pk_bf16_f32 v33, 0, v31
    v_cvt_pk_bf16_f32 v45, 0, v43
    v_mul_f32 v32, v32, v28
    v_mul_f32 v44, v44, v40
    v_mul_f32 v33, v33, v29
    v_mul_f32 v45, v45, v41
    v_cvt_pk_bf16_f32 v64, v32, v33
    v_cvt_pk_bf16_f32 v65, v44, v45
    buffer_store_dwordx2 v[64:65], v6, s[52:55], 0 offen offset:0
    v_cvt_pk_bf16_f32 v26, 0, v124
    v_cvt_pk_bf16_f32 v38, 0, v126
    v_cvt_pk_bf16_f32 v27, 0, v125
    v_cvt_pk_bf16_f32 v39, 0, v127
    v_cvt_pk_bf16_f32 v28, 0, v172
    v_cvt_pk_bf16_f32 v40, 0, v174
    v_cvt_pk_bf16_f32 v29, 0, v173
    v_cvt_pk_bf16_f32 v41, 0, v175
    v_mul_f32 v30, v26, v26
    v_mul_f32 v42, v38, v38
    v_mul_f32 v31, v27, v27
    v_mul_f32 v43, v39, v39
    v_fma_f32 v30, v30, v18, v16
    v_fma_f32 v42, v42, v18, v16
    v_fma_f32 v31, v31, v18, v16
    v_fma_f32 v43, v43, v18, v16
    v_mul_f32 v30, v30, v26
    v_mul_f32 v42, v42, v38
    v_mul_f32 v31, v31, v27
    v_mul_f32 v43, v43, v39
    v_exp_f32 v30, v30
    v_exp_f32 v42, v42
    v_exp_f32 v31, v31
    v_exp_f32 v43, v43
    v_add_f32 v30, 1.0, v30
    v_add_f32 v42, 1.0, v42
    v_add_f32 v31, 1.0, v31
    v_add_f32 v43, 1.0, v43
    v_rcp_f32 v30, v30
    v_rcp_f32 v42, v42
    v_rcp_f32 v31, v31
    v_rcp_f32 v43, v43
    v_mul_f32 v30, v30, v26
    v_mul_f32 v42, v42, v38
    v_mul_f32 v31, v31, v27
    v_mul_f32 v43, v43, v39
    v_cvt_pk_bf16_f32 v32, 0, v30
    v_cvt_pk_bf16_f32 v44, 0, v42
    v_cvt_pk_bf16_f32 v33, 0, v31
    v_cvt_pk_bf16_f32 v45, 0, v43
    v_mul_f32 v32, v32, v28
    v_mul_f32 v44, v44, v40
    v_mul_f32 v33, v33, v29
    v_mul_f32 v45, v45, v41
    v_cvt_pk_bf16_f32 v66, v32, v33
    v_cvt_pk_bf16_f32 v67, v44, v45
    buffer_store_dwordx2 v[66:67], v6, s[52:55], 0 offen offset:512
    v_cvt_pk_bf16_f32 v26, 0, v128
    v_cvt_pk_bf16_f32 v38, 0, v130
    v_cvt_pk_bf16_f32 v27, 0, v129
    v_cvt_pk_bf16_f32 v39, 0, v131
    v_cvt_pk_bf16_f32 v28, 0, v176
    v_cvt_pk_bf16_f32 v40, 0, v178
    v_cvt_pk_bf16_f32 v29, 0, v177
    v_cvt_pk_bf16_f32 v41, 0, v179
    v_mul_f32 v30, v26, v26
    v_mul_f32 v42, v38, v38
    v_mul_f32 v31, v27, v27
    v_mul_f32 v43, v39, v39
    v_fma_f32 v30, v30, v18, v16
    v_fma_f32 v42, v42, v18, v16
    v_fma_f32 v31, v31, v18, v16
    v_fma_f32 v43, v43, v18, v16
    v_mul_f32 v30, v30, v26
    v_mul_f32 v42, v42, v38
    v_mul_f32 v31, v31, v27
    v_mul_f32 v43, v43, v39
    v_exp_f32 v30, v30
    v_exp_f32 v42, v42
    v_exp_f32 v31, v31
    v_exp_f32 v43, v43
    v_add_f32 v30, 1.0, v30
    v_add_f32 v42, 1.0, v42
    v_add_f32 v31, 1.0, v31
    v_add_f32 v43, 1.0, v43
    v_rcp_f32 v30, v30
    v_rcp_f32 v42, v42
    v_rcp_f32 v31, v31
    v_rcp_f32 v43, v43
    v_mul_f32 v30, v30, v26
    v_mul_f32 v42, v42, v38
    v_mul_f32 v31, v31, v27
    v_mul_f32 v43, v43, v39
    v_cvt_pk_bf16_f32 v32, 0, v30
    v_cvt_pk_bf16_f32 v44, 0, v42
    v_cvt_pk_bf16_f32 v33, 0, v31
    v_cvt_pk_bf16_f32 v45, 0, v43
    v_mul_f32 v32, v32, v28
    v_mul_f32 v44, v44, v40
    v_mul_f32 v33, v33, v29
    v_mul_f32 v45, v45, v41
    v_cvt_pk_bf16_f32 v64, v32, v33
    v_cvt_pk_bf16_f32 v65, v44, v45
    buffer_store_dwordx2 v[64:65], v6, s[52:55], 0 offen offset:1024
    v_cvt_pk_bf16_f32 v26, 0, v132
    v_cvt_pk_bf16_f32 v38, 0, v134
    v_cvt_pk_bf16_f32 v27, 0, v133
    v_cvt_pk_bf16_f32 v39, 0, v135
    v_cvt_pk_bf16_f32 v28, 0, v180
    v_cvt_pk_bf16_f32 v40, 0, v182
    v_cvt_pk_bf16_f32 v29, 0, v181
    v_cvt_pk_bf16_f32 v41, 0, v183
    v_mul_f32 v30, v26, v26
    v_mul_f32 v42, v38, v38
    v_mul_f32 v31, v27, v27
    v_mul_f32 v43, v39, v39
    v_fma_f32 v30, v30, v18, v16
    v_fma_f32 v42, v42, v18, v16
    v_fma_f32 v31, v31, v18, v16
    v_fma_f32 v43, v43, v18, v16
    v_mul_f32 v30, v30, v26
    v_mul_f32 v42, v42, v38
    v_mul_f32 v31, v31, v27
    v_mul_f32 v43, v43, v39
    v_exp_f32 v30, v30
    v_exp_f32 v42, v42
    v_exp_f32 v31, v31
    v_exp_f32 v43, v43
    v_add_f32 v30, 1.0, v30
    v_add_f32 v42, 1.0, v42
    v_add_f32 v31, 1.0, v31
    v_add_f32 v43, 1.0, v43
    v_rcp_f32 v30, v30
    v_rcp_f32 v42, v42
    v_rcp_f32 v31, v31
    v_rcp_f32 v43, v43
    v_mul_f32 v30, v30, v26
    v_mul_f32 v42, v42, v38
    v_mul_f32 v31, v31, v27
    v_mul_f32 v43, v43, v39
    v_cvt_pk_bf16_f32 v32, 0, v30
    v_cvt_pk_bf16_f32 v44, 0, v42
    v_cvt_pk_bf16_f32 v33, 0, v31
    v_cvt_pk_bf16_f32 v45, 0, v43
    v_mul_f32 v32, v32, v28
    v_mul_f32 v44, v44, v40
    v_mul_f32 v33, v33, v29
    v_mul_f32 v45, v45, v41
    v_cvt_pk_bf16_f32 v66, v32, v33
    v_cvt_pk_bf16_f32 v67, v44, v45
    buffer_store_dwordx2 v[66:67], v6, s[52:55], 0 offen offset:1536
L_g1_done:
    s_nop 0
    s_endpgm
L_gate:
    s_sub_u32 s3, s2, 496
    s_waitcnt lgkmcnt(0)
    s_mov_b32 s48, s16
    s_and_b32 s49, s17, 0xffff
    s_mov_b32 s50, 2097152
    s_mov_b32 s51, 0x00020000
    s_mov_b32 s52, s44
    s_and_b32 s53, s45, 0xffff
    s_mov_b32 s54, 268435456
    s_mov_b32 s55, 0x00020000
    s_mov_b32 s56, s38
    s_and_b32 s57, s39, 0xffff
    s_mov_b32 s58, 1024
    s_mov_b32 s59, 0x00020000
    v_and_b32 v1, 63, v0
    v_lshrrev_b32 v2, 6, v0
    s_nop 0
    v_readfirstlane_b32 s7, v2
    v_lshlrev_b32 v3, 4, v1
    buffer_load_dwordx4 v[4:7], v3, s[56:59], 0 offen
    s_lshl_b32 s8, s3, 7
    s_lshl_b32 s9, s7, 5
    s_add_u32 s8, s8, s9
    s_lshl_b32 s9, s8, 10
    v_add_u32 v2, s9, v3
    v_add_u32 v8, 4096, v2
    v_add_u32 v9, 8192, v2
    v_add_u32 v10, 12288, v2
    v_add_u32 v11, 16384, v2
    v_add_u32 v12, 20480, v2
    v_add_u32 v13, 24576, v2
    v_add_u32 v14, 28672, v2
    buffer_load_dwordx4 v[64:67], v2, s[48:51], 0 offen offset:0
    buffer_load_dwordx4 v[68:71], v2, s[48:51], 0 offen offset:1024
    buffer_load_dwordx4 v[72:75], v2, s[48:51], 0 offen offset:2048
    buffer_load_dwordx4 v[76:79], v2, s[48:51], 0 offen offset:3072
    buffer_load_dwordx4 v[80:83], v8, s[48:51], 0 offen offset:0
    buffer_load_dwordx4 v[84:87], v8, s[48:51], 0 offen offset:1024
    buffer_load_dwordx4 v[88:91], v8, s[48:51], 0 offen offset:2048
    buffer_load_dwordx4 v[92:95], v8, s[48:51], 0 offen offset:3072
    buffer_load_dwordx4 v[96:99], v9, s[48:51], 0 offen offset:0
    buffer_load_dwordx4 v[100:103], v9, s[48:51], 0 offen offset:1024
    buffer_load_dwordx4 v[104:107], v9, s[48:51], 0 offen offset:2048
    buffer_load_dwordx4 v[108:111], v9, s[48:51], 0 offen offset:3072
    buffer_load_dwordx4 v[112:115], v10, s[48:51], 0 offen offset:0
    buffer_load_dwordx4 v[116:119], v10, s[48:51], 0 offen offset:1024
    buffer_load_dwordx4 v[120:123], v10, s[48:51], 0 offen offset:2048
    buffer_load_dwordx4 v[124:127], v10, s[48:51], 0 offen offset:3072
    buffer_load_dwordx4 v[128:131], v11, s[48:51], 0 offen offset:0
    buffer_load_dwordx4 v[132:135], v11, s[48:51], 0 offen offset:1024
    buffer_load_dwordx4 v[136:139], v11, s[48:51], 0 offen offset:2048
    buffer_load_dwordx4 v[140:143], v11, s[48:51], 0 offen offset:3072
    buffer_load_dwordx4 v[144:147], v12, s[48:51], 0 offen offset:0
    buffer_load_dwordx4 v[148:151], v12, s[48:51], 0 offen offset:1024
    buffer_load_dwordx4 v[152:155], v12, s[48:51], 0 offen offset:2048
    buffer_load_dwordx4 v[156:159], v12, s[48:51], 0 offen offset:3072
    buffer_load_dwordx4 v[160:163], v13, s[48:51], 0 offen offset:0
    buffer_load_dwordx4 v[164:167], v13, s[48:51], 0 offen offset:1024
    buffer_load_dwordx4 v[168:171], v13, s[48:51], 0 offen offset:2048
    buffer_load_dwordx4 v[172:175], v13, s[48:51], 0 offen offset:3072
    buffer_load_dwordx4 v[176:179], v14, s[48:51], 0 offen offset:0
    buffer_load_dwordx4 v[180:183], v14, s[48:51], 0 offen offset:1024
    buffer_load_dwordx4 v[184:187], v14, s[48:51], 0 offen offset:2048
    buffer_load_dwordx4 v[188:191], v14, s[48:51], 0 offen offset:3072
    s_waitcnt vmcnt(32)
    v_lshlrev_b32 v16, 16, v4
    v_and_b32 v17, 0xffff0000, v4
    v_lshlrev_b32 v18, 16, v5
    v_and_b32 v19, 0xffff0000, v5
    v_lshlrev_b32 v20, 16, v6
    v_and_b32 v21, 0xffff0000, v6
    v_lshlrev_b32 v22, 16, v7
    v_and_b32 v23, 0xffff0000, v7
    s_waitcnt vmcnt(31)
    v_lshlrev_b32 v24, 16, v64
    v_and_b32 v25, 0xffff0000, v64
    v_mul_f32 v24, v24, v16
    v_mul_f32 v25, v25, v17
    v_cvt_pk_bf16_f32 v24, v24, v25
    v_lshlrev_b32 v25, 16, v24
    v_and_b32 v24, 0xffff0000, v24
    v_add_f32 v192, v24, v25
    v_lshlrev_b32 v24, 16, v65
    v_and_b32 v25, 0xffff0000, v65
    v_mul_f32 v24, v24, v18
    v_mul_f32 v25, v25, v19
    v_cvt_pk_bf16_f32 v24, v24, v25
    v_lshlrev_b32 v25, 16, v24
    v_and_b32 v24, 0xffff0000, v24
    v_add_f32 v192, v192, v24
    v_add_f32 v192, v192, v25
    v_lshlrev_b32 v24, 16, v66
    v_and_b32 v25, 0xffff0000, v66
    v_mul_f32 v24, v24, v20
    v_mul_f32 v25, v25, v21
    v_cvt_pk_bf16_f32 v24, v24, v25
    v_lshlrev_b32 v25, 16, v24
    v_and_b32 v24, 0xffff0000, v24
    v_add_f32 v192, v192, v24
    v_add_f32 v192, v192, v25
    v_lshlrev_b32 v24, 16, v67
    v_and_b32 v25, 0xffff0000, v67
    v_mul_f32 v24, v24, v22
    v_mul_f32 v25, v25, v23
    v_cvt_pk_bf16_f32 v24, v24, v25
    v_lshlrev_b32 v25, 16, v24
    v_and_b32 v24, 0xffff0000, v24
    v_add_f32 v192, v192, v24
    v_add_f32 v192, v192, v25
    s_waitcnt vmcnt(30)
    v_lshlrev_b32 v24, 16, v68
    v_and_b32 v25, 0xffff0000, v68
    v_mul_f32 v24, v24, v16
    v_mul_f32 v25, v25, v17
    v_cvt_pk_bf16_f32 v24, v24, v25
    v_lshlrev_b32 v25, 16, v24
    v_and_b32 v24, 0xffff0000, v24
    v_add_f32 v193, v24, v25
    v_lshlrev_b32 v24, 16, v69
    v_and_b32 v25, 0xffff0000, v69
    v_mul_f32 v24, v24, v18
    v_mul_f32 v25, v25, v19
    v_cvt_pk_bf16_f32 v24, v24, v25
    v_lshlrev_b32 v25, 16, v24
    v_and_b32 v24, 0xffff0000, v24
    v_add_f32 v193, v193, v24
    v_add_f32 v193, v193, v25
    v_lshlrev_b32 v24, 16, v70
    v_and_b32 v25, 0xffff0000, v70
    v_mul_f32 v24, v24, v20
    v_mul_f32 v25, v25, v21
    v_cvt_pk_bf16_f32 v24, v24, v25
    v_lshlrev_b32 v25, 16, v24
    v_and_b32 v24, 0xffff0000, v24
    v_add_f32 v193, v193, v24
    v_add_f32 v193, v193, v25
    v_lshlrev_b32 v24, 16, v71
    v_and_b32 v25, 0xffff0000, v71
    v_mul_f32 v24, v24, v22
    v_mul_f32 v25, v25, v23
    v_cvt_pk_bf16_f32 v24, v24, v25
    v_lshlrev_b32 v25, 16, v24
    v_and_b32 v24, 0xffff0000, v24
    v_add_f32 v193, v193, v24
    v_add_f32 v193, v193, v25
    s_waitcnt vmcnt(29)
    v_lshlrev_b32 v24, 16, v72
    v_and_b32 v25, 0xffff0000, v72
    v_mul_f32 v24, v24, v16
    v_mul_f32 v25, v25, v17
    v_cvt_pk_bf16_f32 v24, v24, v25
    v_lshlrev_b32 v25, 16, v24
    v_and_b32 v24, 0xffff0000, v24
    v_add_f32 v194, v24, v25
    v_lshlrev_b32 v24, 16, v73
    v_and_b32 v25, 0xffff0000, v73
    v_mul_f32 v24, v24, v18
    v_mul_f32 v25, v25, v19
    v_cvt_pk_bf16_f32 v24, v24, v25
    v_lshlrev_b32 v25, 16, v24
    v_and_b32 v24, 0xffff0000, v24
    v_add_f32 v194, v194, v24
    v_add_f32 v194, v194, v25
    v_lshlrev_b32 v24, 16, v74
    v_and_b32 v25, 0xffff0000, v74
    v_mul_f32 v24, v24, v20
    v_mul_f32 v25, v25, v21
    v_cvt_pk_bf16_f32 v24, v24, v25
    v_lshlrev_b32 v25, 16, v24
    v_and_b32 v24, 0xffff0000, v24
    v_add_f32 v194, v194, v24
    v_add_f32 v194, v194, v25
    v_lshlrev_b32 v24, 16, v75
    v_and_b32 v25, 0xffff0000, v75
    v_mul_f32 v24, v24, v22
    v_mul_f32 v25, v25, v23
    v_cvt_pk_bf16_f32 v24, v24, v25
    v_lshlrev_b32 v25, 16, v24
    v_and_b32 v24, 0xffff0000, v24
    v_add_f32 v194, v194, v24
    v_add_f32 v194, v194, v25
    s_waitcnt vmcnt(28)
    v_lshlrev_b32 v24, 16, v76
    v_and_b32 v25, 0xffff0000, v76
    v_mul_f32 v24, v24, v16
    v_mul_f32 v25, v25, v17
    v_cvt_pk_bf16_f32 v24, v24, v25
    v_lshlrev_b32 v25, 16, v24
    v_and_b32 v24, 0xffff0000, v24
    v_add_f32 v195, v24, v25
    v_lshlrev_b32 v24, 16, v77
    v_and_b32 v25, 0xffff0000, v77
    v_mul_f32 v24, v24, v18
    v_mul_f32 v25, v25, v19
    v_cvt_pk_bf16_f32 v24, v24, v25
    v_lshlrev_b32 v25, 16, v24
    v_and_b32 v24, 0xffff0000, v24
    v_add_f32 v195, v195, v24
    v_add_f32 v195, v195, v25
    v_lshlrev_b32 v24, 16, v78
    v_and_b32 v25, 0xffff0000, v78
    v_mul_f32 v24, v24, v20
    v_mul_f32 v25, v25, v21
    v_cvt_pk_bf16_f32 v24, v24, v25
    v_lshlrev_b32 v25, 16, v24
    v_and_b32 v24, 0xffff0000, v24
    v_add_f32 v195, v195, v24
    v_add_f32 v195, v195, v25
    v_lshlrev_b32 v24, 16, v79
    v_and_b32 v25, 0xffff0000, v79
    v_mul_f32 v24, v24, v22
    v_mul_f32 v25, v25, v23
    v_cvt_pk_bf16_f32 v24, v24, v25
    v_lshlrev_b32 v25, 16, v24
    v_and_b32 v24, 0xffff0000, v24
    v_add_f32 v195, v195, v24
    v_add_f32 v195, v195, v25
    s_waitcnt vmcnt(27)
    v_lshlrev_b32 v24, 16, v80
    v_and_b32 v25, 0xffff0000, v80
    v_mul_f32 v24, v24, v16
    v_mul_f32 v25, v25, v17
    v_cvt_pk_bf16_f32 v24, v24, v25
    v_lshlrev_b32 v25, 16, v24
    v_and_b32 v24, 0xffff0000, v24
    v_add_f32 v196, v24, v25
    v_lshlrev_b32 v24, 16, v81
    v_and_b32 v25, 0xffff0000, v81
    v_mul_f32 v24, v24, v18
    v_mul_f32 v25, v25, v19
    v_cvt_pk_bf16_f32 v24, v24, v25
    v_lshlrev_b32 v25, 16, v24
    v_and_b32 v24, 0xffff0000, v24
    v_add_f32 v196, v196, v24
    v_add_f32 v196, v196, v25
    v_lshlrev_b32 v24, 16, v82
    v_and_b32 v25, 0xffff0000, v82
    v_mul_f32 v24, v24, v20
    v_mul_f32 v25, v25, v21
    v_cvt_pk_bf16_f32 v24, v24, v25
    v_lshlrev_b32 v25, 16, v24
    v_and_b32 v24, 0xffff0000, v24
    v_add_f32 v196, v196, v24
    v_add_f32 v196, v196, v25
    v_lshlrev_b32 v24, 16, v83
    v_and_b32 v25, 0xffff0000, v83
    v_mul_f32 v24, v24, v22
    v_mul_f32 v25, v25, v23
    v_cvt_pk_bf16_f32 v24, v24, v25
    v_lshlrev_b32 v25, 16, v24
    v_and_b32 v24, 0xffff0000, v24
    v_add_f32 v196, v196, v24
    v_add_f32 v196, v196, v25
    s_waitcnt vmcnt(26)
    v_lshlrev_b32 v24, 16, v84
    v_and_b32 v25, 0xffff0000, v84
    v_mul_f32 v24, v24, v16
    v_mul_f32 v25, v25, v17
    v_cvt_pk_bf16_f32 v24, v24, v25
    v_lshlrev_b32 v25, 16, v24
    v_and_b32 v24, 0xffff0000, v24
    v_add_f32 v197, v24, v25
    v_lshlrev_b32 v24, 16, v85
    v_and_b32 v25, 0xffff0000, v85
    v_mul_f32 v24, v24, v18
    v_mul_f32 v25, v25, v19
    v_cvt_pk_bf16_f32 v24, v24, v25
    v_lshlrev_b32 v25, 16, v24
    v_and_b32 v24, 0xffff0000, v24
    v_add_f32 v197, v197, v24
    v_add_f32 v197, v197, v25
    v_lshlrev_b32 v24, 16, v86
    v_and_b32 v25, 0xffff0000, v86
    v_mul_f32 v24, v24, v20
    v_mul_f32 v25, v25, v21
    v_cvt_pk_bf16_f32 v24, v24, v25
    v_lshlrev_b32 v25, 16, v24
    v_and_b32 v24, 0xffff0000, v24
    v_add_f32 v197, v197, v24
    v_add_f32 v197, v197, v25
    v_lshlrev_b32 v24, 16, v87
    v_and_b32 v25, 0xffff0000, v87
    v_mul_f32 v24, v24, v22
    v_mul_f32 v25, v25, v23
    v_cvt_pk_bf16_f32 v24, v24, v25
    v_lshlrev_b32 v25, 16, v24
    v_and_b32 v24, 0xffff0000, v24
    v_add_f32 v197, v197, v24
    v_add_f32 v197, v197, v25
    s_waitcnt vmcnt(25)
    v_lshlrev_b32 v24, 16, v88
    v_and_b32 v25, 0xffff0000, v88
    v_mul_f32 v24, v24, v16
    v_mul_f32 v25, v25, v17
    v_cvt_pk_bf16_f32 v24, v24, v25
    v_lshlrev_b32 v25, 16, v24
    v_and_b32 v24, 0xffff0000, v24
    v_add_f32 v198, v24, v25
    v_lshlrev_b32 v24, 16, v89
    v_and_b32 v25, 0xffff0000, v89
    v_mul_f32 v24, v24, v18
    v_mul_f32 v25, v25, v19
    v_cvt_pk_bf16_f32 v24, v24, v25
    v_lshlrev_b32 v25, 16, v24
    v_and_b32 v24, 0xffff0000, v24
    v_add_f32 v198, v198, v24
    v_add_f32 v198, v198, v25
    v_lshlrev_b32 v24, 16, v90
    v_and_b32 v25, 0xffff0000, v90
    v_mul_f32 v24, v24, v20
    v_mul_f32 v25, v25, v21
    v_cvt_pk_bf16_f32 v24, v24, v25
    v_lshlrev_b32 v25, 16, v24
    v_and_b32 v24, 0xffff0000, v24
    v_add_f32 v198, v198, v24
    v_add_f32 v198, v198, v25
    v_lshlrev_b32 v24, 16, v91
    v_and_b32 v25, 0xffff0000, v91
    v_mul_f32 v24, v24, v22
    v_mul_f32 v25, v25, v23
    v_cvt_pk_bf16_f32 v24, v24, v25
    v_lshlrev_b32 v25, 16, v24
    v_and_b32 v24, 0xffff0000, v24
    v_add_f32 v198, v198, v24
    v_add_f32 v198, v198, v25
    s_waitcnt vmcnt(24)
    v_lshlrev_b32 v24, 16, v92
    v_and_b32 v25, 0xffff0000, v92
    v_mul_f32 v24, v24, v16
    v_mul_f32 v25, v25, v17
    v_cvt_pk_bf16_f32 v24, v24, v25
    v_lshlrev_b32 v25, 16, v24
    v_and_b32 v24, 0xffff0000, v24
    v_add_f32 v199, v24, v25
    v_lshlrev_b32 v24, 16, v93
    v_and_b32 v25, 0xffff0000, v93
    v_mul_f32 v24, v24, v18
    v_mul_f32 v25, v25, v19
    v_cvt_pk_bf16_f32 v24, v24, v25
    v_lshlrev_b32 v25, 16, v24
    v_and_b32 v24, 0xffff0000, v24
    v_add_f32 v199, v199, v24
    v_add_f32 v199, v199, v25
    v_lshlrev_b32 v24, 16, v94
    v_and_b32 v25, 0xffff0000, v94
    v_mul_f32 v24, v24, v20
    v_mul_f32 v25, v25, v21
    v_cvt_pk_bf16_f32 v24, v24, v25
    v_lshlrev_b32 v25, 16, v24
    v_and_b32 v24, 0xffff0000, v24
    v_add_f32 v199, v199, v24
    v_add_f32 v199, v199, v25
    v_lshlrev_b32 v24, 16, v95
    v_and_b32 v25, 0xffff0000, v95
    v_mul_f32 v24, v24, v22
    v_mul_f32 v25, v25, v23
    v_cvt_pk_bf16_f32 v24, v24, v25
    v_lshlrev_b32 v25, 16, v24
    v_and_b32 v24, 0xffff0000, v24
    v_add_f32 v199, v199, v24
    v_add_f32 v199, v199, v25
    s_waitcnt vmcnt(23)
    v_lshlrev_b32 v24, 16, v96
    v_and_b32 v25, 0xffff0000, v96
    v_mul_f32 v24, v24, v16
    v_mul_f32 v25, v25, v17
    v_cvt_pk_bf16_f32 v24, v24, v25
    v_lshlrev_b32 v25, 16, v24
    v_and_b32 v24, 0xffff0000, v24
    v_add_f32 v200, v24, v25
    v_lshlrev_b32 v24, 16, v97
    v_and_b32 v25, 0xffff0000, v97
    v_mul_f32 v24, v24, v18
    v_mul_f32 v25, v25, v19
    v_cvt_pk_bf16_f32 v24, v24, v25
    v_lshlrev_b32 v25, 16, v24
    v_and_b32 v24, 0xffff0000, v24
    v_add_f32 v200, v200, v24
    v_add_f32 v200, v200, v25
    v_lshlrev_b32 v24, 16, v98
    v_and_b32 v25, 0xffff0000, v98
    v_mul_f32 v24, v24, v20
    v_mul_f32 v25, v25, v21
    v_cvt_pk_bf16_f32 v24, v24, v25
    v_lshlrev_b32 v25, 16, v24
    v_and_b32 v24, 0xffff0000, v24
    v_add_f32 v200, v200, v24
    v_add_f32 v200, v200, v25
    v_lshlrev_b32 v24, 16, v99
    v_and_b32 v25, 0xffff0000, v99
    v_mul_f32 v24, v24, v22
    v_mul_f32 v25, v25, v23
    v_cvt_pk_bf16_f32 v24, v24, v25
    v_lshlrev_b32 v25, 16, v24
    v_and_b32 v24, 0xffff0000, v24
    v_add_f32 v200, v200, v24
    v_add_f32 v200, v200, v25
    s_waitcnt vmcnt(22)
    v_lshlrev_b32 v24, 16, v100
    v_and_b32 v25, 0xffff0000, v100
    v_mul_f32 v24, v24, v16
    v_mul_f32 v25, v25, v17
    v_cvt_pk_bf16_f32 v24, v24, v25
    v_lshlrev_b32 v25, 16, v24
    v_and_b32 v24, 0xffff0000, v24
    v_add_f32 v201, v24, v25
    v_lshlrev_b32 v24, 16, v101
    v_and_b32 v25, 0xffff0000, v101
    v_mul_f32 v24, v24, v18
    v_mul_f32 v25, v25, v19
    v_cvt_pk_bf16_f32 v24, v24, v25
    v_lshlrev_b32 v25, 16, v24
    v_and_b32 v24, 0xffff0000, v24
    v_add_f32 v201, v201, v24
    v_add_f32 v201, v201, v25
    v_lshlrev_b32 v24, 16, v102
    v_and_b32 v25, 0xffff0000, v102
    v_mul_f32 v24, v24, v20
    v_mul_f32 v25, v25, v21
    v_cvt_pk_bf16_f32 v24, v24, v25
    v_lshlrev_b32 v25, 16, v24
    v_and_b32 v24, 0xffff0000, v24
    v_add_f32 v201, v201, v24
    v_add_f32 v201, v201, v25
    v_lshlrev_b32 v24, 16, v103
    v_and_b32 v25, 0xffff0000, v103
    v_mul_f32 v24, v24, v22
    v_mul_f32 v25, v25, v23
    v_cvt_pk_bf16_f32 v24, v24, v25
    v_lshlrev_b32 v25, 16, v24
    v_and_b32 v24, 0xffff0000, v24
    v_add_f32 v201, v201, v24
    v_add_f32 v201, v201, v25
    s_waitcnt vmcnt(21)
    v_lshlrev_b32 v24, 16, v104
    v_and_b32 v25, 0xffff0000, v104
    v_mul_f32 v24, v24, v16
    v_mul_f32 v25, v25, v17
    v_cvt_pk_bf16_f32 v24, v24, v25
    v_lshlrev_b32 v25, 16, v24
    v_and_b32 v24, 0xffff0000, v24
    v_add_f32 v202, v24, v25
    v_lshlrev_b32 v24, 16, v105
    v_and_b32 v25, 0xffff0000, v105
    v_mul_f32 v24, v24, v18
    v_mul_f32 v25, v25, v19
    v_cvt_pk_bf16_f32 v24, v24, v25
    v_lshlrev_b32 v25, 16, v24
    v_and_b32 v24, 0xffff0000, v24
    v_add_f32 v202, v202, v24
    v_add_f32 v202, v202, v25
    v_lshlrev_b32 v24, 16, v106
    v_and_b32 v25, 0xffff0000, v106
    v_mul_f32 v24, v24, v20
    v_mul_f32 v25, v25, v21
    v_cvt_pk_bf16_f32 v24, v24, v25
    v_lshlrev_b32 v25, 16, v24
    v_and_b32 v24, 0xffff0000, v24
    v_add_f32 v202, v202, v24
    v_add_f32 v202, v202, v25
    v_lshlrev_b32 v24, 16, v107
    v_and_b32 v25, 0xffff0000, v107
    v_mul_f32 v24, v24, v22
    v_mul_f32 v25, v25, v23
    v_cvt_pk_bf16_f32 v24, v24, v25
    v_lshlrev_b32 v25, 16, v24
    v_and_b32 v24, 0xffff0000, v24
    v_add_f32 v202, v202, v24
    v_add_f32 v202, v202, v25
    s_waitcnt vmcnt(20)
    v_lshlrev_b32 v24, 16, v108
    v_and_b32 v25, 0xffff0000, v108
    v_mul_f32 v24, v24, v16
    v_mul_f32 v25, v25, v17
    v_cvt_pk_bf16_f32 v24, v24, v25
    v_lshlrev_b32 v25, 16, v24
    v_and_b32 v24, 0xffff0000, v24
    v_add_f32 v203, v24, v25
    v_lshlrev_b32 v24, 16, v109
    v_and_b32 v25, 0xffff0000, v109
    v_mul_f32 v24, v24, v18
    v_mul_f32 v25, v25, v19
    v_cvt_pk_bf16_f32 v24, v24, v25
    v_lshlrev_b32 v25, 16, v24
    v_and_b32 v24, 0xffff0000, v24
    v_add_f32 v203, v203, v24
    v_add_f32 v203, v203, v25
    v_lshlrev_b32 v24, 16, v110
    v_and_b32 v25, 0xffff0000, v110
    v_mul_f32 v24, v24, v20
    v_mul_f32 v25, v25, v21
    v_cvt_pk_bf16_f32 v24, v24, v25
    v_lshlrev_b32 v25, 16, v24
    v_and_b32 v24, 0xffff0000, v24
    v_add_f32 v203, v203, v24
    v_add_f32 v203, v203, v25
    v_lshlrev_b32 v24, 16, v111
    v_and_b32 v25, 0xffff0000, v111
    v_mul_f32 v24, v24, v22
    v_mul_f32 v25, v25, v23
    v_cvt_pk_bf16_f32 v24, v24, v25
    v_lshlrev_b32 v25, 16, v24
    v_and_b32 v24, 0xffff0000, v24
    v_add_f32 v203, v203, v24
    v_add_f32 v203, v203, v25
    s_waitcnt vmcnt(19)
    v_lshlrev_b32 v24, 16, v112
    v_and_b32 v25, 0xffff0000, v112
    v_mul_f32 v24, v24, v16
    v_mul_f32 v25, v25, v17
    v_cvt_pk_bf16_f32 v24, v24, v25
    v_lshlrev_b32 v25, 16, v24
    v_and_b32 v24, 0xffff0000, v24
    v_add_f32 v204, v24, v25
    v_lshlrev_b32 v24, 16, v113
    v_and_b32 v25, 0xffff0000, v113
    v_mul_f32 v24, v24, v18
    v_mul_f32 v25, v25, v19
    v_cvt_pk_bf16_f32 v24, v24, v25
    v_lshlrev_b32 v25, 16, v24
    v_and_b32 v24, 0xffff0000, v24
    v_add_f32 v204, v204, v24
    v_add_f32 v204, v204, v25
    v_lshlrev_b32 v24, 16, v114
    v_and_b32 v25, 0xffff0000, v114
    v_mul_f32 v24, v24, v20
    v_mul_f32 v25, v25, v21
    v_cvt_pk_bf16_f32 v24, v24, v25
    v_lshlrev_b32 v25, 16, v24
    v_and_b32 v24, 0xffff0000, v24
    v_add_f32 v204, v204, v24
    v_add_f32 v204, v204, v25
    v_lshlrev_b32 v24, 16, v115
    v_and_b32 v25, 0xffff0000, v115
    v_mul_f32 v24, v24, v22
    v_mul_f32 v25, v25, v23
    v_cvt_pk_bf16_f32 v24, v24, v25
    v_lshlrev_b32 v25, 16, v24
    v_and_b32 v24, 0xffff0000, v24
    v_add_f32 v204, v204, v24
    v_add_f32 v204, v204, v25
    s_waitcnt vmcnt(18)
    v_lshlrev_b32 v24, 16, v116
    v_and_b32 v25, 0xffff0000, v116
    v_mul_f32 v24, v24, v16
    v_mul_f32 v25, v25, v17
    v_cvt_pk_bf16_f32 v24, v24, v25
    v_lshlrev_b32 v25, 16, v24
    v_and_b32 v24, 0xffff0000, v24
    v_add_f32 v205, v24, v25
    v_lshlrev_b32 v24, 16, v117
    v_and_b32 v25, 0xffff0000, v117
    v_mul_f32 v24, v24, v18
    v_mul_f32 v25, v25, v19
    v_cvt_pk_bf16_f32 v24, v24, v25
    v_lshlrev_b32 v25, 16, v24
    v_and_b32 v24, 0xffff0000, v24
    v_add_f32 v205, v205, v24
    v_add_f32 v205, v205, v25
    v_lshlrev_b32 v24, 16, v118
    v_and_b32 v25, 0xffff0000, v118
    v_mul_f32 v24, v24, v20
    v_mul_f32 v25, v25, v21
    v_cvt_pk_bf16_f32 v24, v24, v25
    v_lshlrev_b32 v25, 16, v24
    v_and_b32 v24, 0xffff0000, v24
    v_add_f32 v205, v205, v24
    v_add_f32 v205, v205, v25
    v_lshlrev_b32 v24, 16, v119
    v_and_b32 v25, 0xffff0000, v119
    v_mul_f32 v24, v24, v22
    v_mul_f32 v25, v25, v23
    v_cvt_pk_bf16_f32 v24, v24, v25
    v_lshlrev_b32 v25, 16, v24
    v_and_b32 v24, 0xffff0000, v24
    v_add_f32 v205, v205, v24
    v_add_f32 v205, v205, v25
    s_waitcnt vmcnt(17)
    v_lshlrev_b32 v24, 16, v120
    v_and_b32 v25, 0xffff0000, v120
    v_mul_f32 v24, v24, v16
    v_mul_f32 v25, v25, v17
    v_cvt_pk_bf16_f32 v24, v24, v25
    v_lshlrev_b32 v25, 16, v24
    v_and_b32 v24, 0xffff0000, v24
    v_add_f32 v206, v24, v25
    v_lshlrev_b32 v24, 16, v121
    v_and_b32 v25, 0xffff0000, v121
    v_mul_f32 v24, v24, v18
    v_mul_f32 v25, v25, v19
    v_cvt_pk_bf16_f32 v24, v24, v25
    v_lshlrev_b32 v25, 16, v24
    v_and_b32 v24, 0xffff0000, v24
    v_add_f32 v206, v206, v24
    v_add_f32 v206, v206, v25
    v_lshlrev_b32 v24, 16, v122
    v_and_b32 v25, 0xffff0000, v122
    v_mul_f32 v24, v24, v20
    v_mul_f32 v25, v25, v21
    v_cvt_pk_bf16_f32 v24, v24, v25
    v_lshlrev_b32 v25, 16, v24
    v_and_b32 v24, 0xffff0000, v24
    v_add_f32 v206, v206, v24
    v_add_f32 v206, v206, v25
    v_lshlrev_b32 v24, 16, v123
    v_and_b32 v25, 0xffff0000, v123
    v_mul_f32 v24, v24, v22
    v_mul_f32 v25, v25, v23
    v_cvt_pk_bf16_f32 v24, v24, v25
    v_lshlrev_b32 v25, 16, v24
    v_and_b32 v24, 0xffff0000, v24
    v_add_f32 v206, v206, v24
    v_add_f32 v206, v206, v25
    s_waitcnt vmcnt(16)
    v_lshlrev_b32 v24, 16, v124
    v_and_b32 v25, 0xffff0000, v124
    v_mul_f32 v24, v24, v16
    v_mul_f32 v25, v25, v17
    v_cvt_pk_bf16_f32 v24, v24, v25
    v_lshlrev_b32 v25, 16, v24
    v_and_b32 v24, 0xffff0000, v24
    v_add_f32 v207, v24, v25
    v_lshlrev_b32 v24, 16, v125
    v_and_b32 v25, 0xffff0000, v125
    v_mul_f32 v24, v24, v18
    v_mul_f32 v25, v25, v19
    v_cvt_pk_bf16_f32 v24, v24, v25
    v_lshlrev_b32 v25, 16, v24
    v_and_b32 v24, 0xffff0000, v24
    v_add_f32 v207, v207, v24
    v_add_f32 v207, v207, v25
    v_lshlrev_b32 v24, 16, v126
    v_and_b32 v25, 0xffff0000, v126
    v_mul_f32 v24, v24, v20
    v_mul_f32 v25, v25, v21
    v_cvt_pk_bf16_f32 v24, v24, v25
    v_lshlrev_b32 v25, 16, v24
    v_and_b32 v24, 0xffff0000, v24
    v_add_f32 v207, v207, v24
    v_add_f32 v207, v207, v25
    v_lshlrev_b32 v24, 16, v127
    v_and_b32 v25, 0xffff0000, v127
    v_mul_f32 v24, v24, v22
    v_mul_f32 v25, v25, v23
    v_cvt_pk_bf16_f32 v24, v24, v25
    v_lshlrev_b32 v25, 16, v24
    v_and_b32 v24, 0xffff0000, v24
    v_add_f32 v207, v207, v24
    v_add_f32 v207, v207, v25
    s_waitcnt vmcnt(15)
    v_lshlrev_b32 v24, 16, v128
    v_and_b32 v25, 0xffff0000, v128
    v_mul_f32 v24, v24, v16
    v_mul_f32 v25, v25, v17
    v_cvt_pk_bf16_f32 v24, v24, v25
    v_lshlrev_b32 v25, 16, v24
    v_and_b32 v24, 0xffff0000, v24
    v_add_f32 v208, v24, v25
    v_lshlrev_b32 v24, 16, v129
    v_and_b32 v25, 0xffff0000, v129
    v_mul_f32 v24, v24, v18
    v_mul_f32 v25, v25, v19
    v_cvt_pk_bf16_f32 v24, v24, v25
    v_lshlrev_b32 v25, 16, v24
    v_and_b32 v24, 0xffff0000, v24
    v_add_f32 v208, v208, v24
    v_add_f32 v208, v208, v25
    v_lshlrev_b32 v24, 16, v130
    v_and_b32 v25, 0xffff0000, v130
    v_mul_f32 v24, v24, v20
    v_mul_f32 v25, v25, v21
    v_cvt_pk_bf16_f32 v24, v24, v25
    v_lshlrev_b32 v25, 16, v24
    v_and_b32 v24, 0xffff0000, v24
    v_add_f32 v208, v208, v24
    v_add_f32 v208, v208, v25
    v_lshlrev_b32 v24, 16, v131
    v_and_b32 v25, 0xffff0000, v131
    v_mul_f32 v24, v24, v22
    v_mul_f32 v25, v25, v23
    v_cvt_pk_bf16_f32 v24, v24, v25
    v_lshlrev_b32 v25, 16, v24
    v_and_b32 v24, 0xffff0000, v24
    v_add_f32 v208, v208, v24
    v_add_f32 v208, v208, v25
    s_waitcnt vmcnt(14)
    v_lshlrev_b32 v24, 16, v132
    v_and_b32 v25, 0xffff0000, v132
    v_mul_f32 v24, v24, v16
    v_mul_f32 v25, v25, v17
    v_cvt_pk_bf16_f32 v24, v24, v25
    v_lshlrev_b32 v25, 16, v24
    v_and_b32 v24, 0xffff0000, v24
    v_add_f32 v209, v24, v25
    v_lshlrev_b32 v24, 16, v133
    v_and_b32 v25, 0xffff0000, v133
    v_mul_f32 v24, v24, v18
    v_mul_f32 v25, v25, v19
    v_cvt_pk_bf16_f32 v24, v24, v25
    v_lshlrev_b32 v25, 16, v24
    v_and_b32 v24, 0xffff0000, v24
    v_add_f32 v209, v209, v24
    v_add_f32 v209, v209, v25
    v_lshlrev_b32 v24, 16, v134
    v_and_b32 v25, 0xffff0000, v134
    v_mul_f32 v24, v24, v20
    v_mul_f32 v25, v25, v21
    v_cvt_pk_bf16_f32 v24, v24, v25
    v_lshlrev_b32 v25, 16, v24
    v_and_b32 v24, 0xffff0000, v24
    v_add_f32 v209, v209, v24
    v_add_f32 v209, v209, v25
    v_lshlrev_b32 v24, 16, v135
    v_and_b32 v25, 0xffff0000, v135
    v_mul_f32 v24, v24, v22
    v_mul_f32 v25, v25, v23
    v_cvt_pk_bf16_f32 v24, v24, v25
    v_lshlrev_b32 v25, 16, v24
    v_and_b32 v24, 0xffff0000, v24
    v_add_f32 v209, v209, v24
    v_add_f32 v209, v209, v25
    s_waitcnt vmcnt(13)
    v_lshlrev_b32 v24, 16, v136
    v_and_b32 v25, 0xffff0000, v136
    v_mul_f32 v24, v24, v16
    v_mul_f32 v25, v25, v17
    v_cvt_pk_bf16_f32 v24, v24, v25
    v_lshlrev_b32 v25, 16, v24
    v_and_b32 v24, 0xffff0000, v24
    v_add_f32 v210, v24, v25
    v_lshlrev_b32 v24, 16, v137
    v_and_b32 v25, 0xffff0000, v137
    v_mul_f32 v24, v24, v18
    v_mul_f32 v25, v25, v19
    v_cvt_pk_bf16_f32 v24, v24, v25
    v_lshlrev_b32 v25, 16, v24
    v_and_b32 v24, 0xffff0000, v24
    v_add_f32 v210, v210, v24
    v_add_f32 v210, v210, v25
    v_lshlrev_b32 v24, 16, v138
    v_and_b32 v25, 0xffff0000, v138
    v_mul_f32 v24, v24, v20
    v_mul_f32 v25, v25, v21
    v_cvt_pk_bf16_f32 v24, v24, v25
    v_lshlrev_b32 v25, 16, v24
    v_and_b32 v24, 0xffff0000, v24
    v_add_f32 v210, v210, v24
    v_add_f32 v210, v210, v25
    v_lshlrev_b32 v24, 16, v139
    v_and_b32 v25, 0xffff0000, v139
    v_mul_f32 v24, v24, v22
    v_mul_f32 v25, v25, v23
    v_cvt_pk_bf16_f32 v24, v24, v25
    v_lshlrev_b32 v25, 16, v24
    v_and_b32 v24, 0xffff0000, v24
    v_add_f32 v210, v210, v24
    v_add_f32 v210, v210, v25
    s_waitcnt vmcnt(12)
    v_lshlrev_b32 v24, 16, v140
    v_and_b32 v25, 0xffff0000, v140
    v_mul_f32 v24, v24, v16
    v_mul_f32 v25, v25, v17
    v_cvt_pk_bf16_f32 v24, v24, v25
    v_lshlrev_b32 v25, 16, v24
    v_and_b32 v24, 0xffff0000, v24
    v_add_f32 v211, v24, v25
    v_lshlrev_b32 v24, 16, v141
    v_and_b32 v25, 0xffff0000, v141
    v_mul_f32 v24, v24, v18
    v_mul_f32 v25, v25, v19
    v_cvt_pk_bf16_f32 v24, v24, v25
    v_lshlrev_b32 v25, 16, v24
    v_and_b32 v24, 0xffff0000, v24
    v_add_f32 v211, v211, v24
    v_add_f32 v211, v211, v25
    v_lshlrev_b32 v24, 16, v142
    v_and_b32 v25, 0xffff0000, v142
    v_mul_f32 v24, v24, v20
    v_mul_f32 v25, v25, v21
    v_cvt_pk_bf16_f32 v24, v24, v25
    v_lshlrev_b32 v25, 16, v24
    v_and_b32 v24, 0xffff0000, v24
    v_add_f32 v211, v211, v24
    v_add_f32 v211, v211, v25
    v_lshlrev_b32 v24, 16, v143
    v_and_b32 v25, 0xffff0000, v143
    v_mul_f32 v24, v24, v22
    v_mul_f32 v25, v25, v23
    v_cvt_pk_bf16_f32 v24, v24, v25
    v_lshlrev_b32 v25, 16, v24
    v_and_b32 v24, 0xffff0000, v24
    v_add_f32 v211, v211, v24
    v_add_f32 v211, v211, v25
    s_waitcnt vmcnt(11)
    v_lshlrev_b32 v24, 16, v144
    v_and_b32 v25, 0xffff0000, v144
    v_mul_f32 v24, v24, v16
    v_mul_f32 v25, v25, v17
    v_cvt_pk_bf16_f32 v24, v24, v25
    v_lshlrev_b32 v25, 16, v24
    v_and_b32 v24, 0xffff0000, v24
    v_add_f32 v212, v24, v25
    v_lshlrev_b32 v24, 16, v145
    v_and_b32 v25, 0xffff0000, v145
    v_mul_f32 v24, v24, v18
    v_mul_f32 v25, v25, v19
    v_cvt_pk_bf16_f32 v24, v24, v25
    v_lshlrev_b32 v25, 16, v24
    v_and_b32 v24, 0xffff0000, v24
    v_add_f32 v212, v212, v24
    v_add_f32 v212, v212, v25
    v_lshlrev_b32 v24, 16, v146
    v_and_b32 v25, 0xffff0000, v146
    v_mul_f32 v24, v24, v20
    v_mul_f32 v25, v25, v21
    v_cvt_pk_bf16_f32 v24, v24, v25
    v_lshlrev_b32 v25, 16, v24
    v_and_b32 v24, 0xffff0000, v24
    v_add_f32 v212, v212, v24
    v_add_f32 v212, v212, v25
    v_lshlrev_b32 v24, 16, v147
    v_and_b32 v25, 0xffff0000, v147
    v_mul_f32 v24, v24, v22
    v_mul_f32 v25, v25, v23
    v_cvt_pk_bf16_f32 v24, v24, v25
    v_lshlrev_b32 v25, 16, v24
    v_and_b32 v24, 0xffff0000, v24
    v_add_f32 v212, v212, v24
    v_add_f32 v212, v212, v25
    s_waitcnt vmcnt(10)
    v_lshlrev_b32 v24, 16, v148
    v_and_b32 v25, 0xffff0000, v148
    v_mul_f32 v24, v24, v16
    v_mul_f32 v25, v25, v17
    v_cvt_pk_bf16_f32 v24, v24, v25
    v_lshlrev_b32 v25, 16, v24
    v_and_b32 v24, 0xffff0000, v24
    v_add_f32 v213, v24, v25
    v_lshlrev_b32 v24, 16, v149
    v_and_b32 v25, 0xffff0000, v149
    v_mul_f32 v24, v24, v18
    v_mul_f32 v25, v25, v19
    v_cvt_pk_bf16_f32 v24, v24, v25
    v_lshlrev_b32 v25, 16, v24
    v_and_b32 v24, 0xffff0000, v24
    v_add_f32 v213, v213, v24
    v_add_f32 v213, v213, v25
    v_lshlrev_b32 v24, 16, v150
    v_and_b32 v25, 0xffff0000, v150
    v_mul_f32 v24, v24, v20
    v_mul_f32 v25, v25, v21
    v_cvt_pk_bf16_f32 v24, v24, v25
    v_lshlrev_b32 v25, 16, v24
    v_and_b32 v24, 0xffff0000, v24
    v_add_f32 v213, v213, v24
    v_add_f32 v213, v213, v25
    v_lshlrev_b32 v24, 16, v151
    v_and_b32 v25, 0xffff0000, v151
    v_mul_f32 v24, v24, v22
    v_mul_f32 v25, v25, v23
    v_cvt_pk_bf16_f32 v24, v24, v25
    v_lshlrev_b32 v25, 16, v24
    v_and_b32 v24, 0xffff0000, v24
    v_add_f32 v213, v213, v24
    v_add_f32 v213, v213, v25
    s_waitcnt vmcnt(9)
    v_lshlrev_b32 v24, 16, v152
    v_and_b32 v25, 0xffff0000, v152
    v_mul_f32 v24, v24, v16
    v_mul_f32 v25, v25, v17
    v_cvt_pk_bf16_f32 v24, v24, v25
    v_lshlrev_b32 v25, 16, v24
    v_and_b32 v24, 0xffff0000, v24
    v_add_f32 v214, v24, v25
    v_lshlrev_b32 v24, 16, v153
    v_and_b32 v25, 0xffff0000, v153
    v_mul_f32 v24, v24, v18
    v_mul_f32 v25, v25, v19
    v_cvt_pk_bf16_f32 v24, v24, v25
    v_lshlrev_b32 v25, 16, v24
    v_and_b32 v24, 0xffff0000, v24
    v_add_f32 v214, v214, v24
    v_add_f32 v214, v214, v25
    v_lshlrev_b32 v24, 16, v154
    v_and_b32 v25, 0xffff0000, v154
    v_mul_f32 v24, v24, v20
    v_mul_f32 v25, v25, v21
    v_cvt_pk_bf16_f32 v24, v24, v25
    v_lshlrev_b32 v25, 16, v24
    v_and_b32 v24, 0xffff0000, v24
    v_add_f32 v214, v214, v24
    v_add_f32 v214, v214, v25
    v_lshlrev_b32 v24, 16, v155
    v_and_b32 v25, 0xffff0000, v155
    v_mul_f32 v24, v24, v22
    v_mul_f32 v25, v25, v23
    v_cvt_pk_bf16_f32 v24, v24, v25
    v_lshlrev_b32 v25, 16, v24
    v_and_b32 v24, 0xffff0000, v24
    v_add_f32 v214, v214, v24
    v_add_f32 v214, v214, v25
    s_waitcnt vmcnt(8)
    v_lshlrev_b32 v24, 16, v156
    v_and_b32 v25, 0xffff0000, v156
    v_mul_f32 v24, v24, v16
    v_mul_f32 v25, v25, v17
    v_cvt_pk_bf16_f32 v24, v24, v25
    v_lshlrev_b32 v25, 16, v24
    v_and_b32 v24, 0xffff0000, v24
    v_add_f32 v215, v24, v25
    v_lshlrev_b32 v24, 16, v157
    v_and_b32 v25, 0xffff0000, v157
    v_mul_f32 v24, v24, v18
    v_mul_f32 v25, v25, v19
    v_cvt_pk_bf16_f32 v24, v24, v25
    v_lshlrev_b32 v25, 16, v24
    v_and_b32 v24, 0xffff0000, v24
    v_add_f32 v215, v215, v24
    v_add_f32 v215, v215, v25
    v_lshlrev_b32 v24, 16, v158
    v_and_b32 v25, 0xffff0000, v158
    v_mul_f32 v24, v24, v20
    v_mul_f32 v25, v25, v21
    v_cvt_pk_bf16_f32 v24, v24, v25
    v_lshlrev_b32 v25, 16, v24
    v_and_b32 v24, 0xffff0000, v24
    v_add_f32 v215, v215, v24
    v_add_f32 v215, v215, v25
    v_lshlrev_b32 v24, 16, v159
    v_and_b32 v25, 0xffff0000, v159
    v_mul_f32 v24, v24, v22
    v_mul_f32 v25, v25, v23
    v_cvt_pk_bf16_f32 v24, v24, v25
    v_lshlrev_b32 v25, 16, v24
    v_and_b32 v24, 0xffff0000, v24
    v_add_f32 v215, v215, v24
    v_add_f32 v215, v215, v25
    s_waitcnt vmcnt(7)
    v_lshlrev_b32 v24, 16, v160
    v_and_b32 v25, 0xffff0000, v160
    v_mul_f32 v24, v24, v16
    v_mul_f32 v25, v25, v17
    v_cvt_pk_bf16_f32 v24, v24, v25
    v_lshlrev_b32 v25, 16, v24
    v_and_b32 v24, 0xffff0000, v24
    v_add_f32 v216, v24, v25
    v_lshlrev_b32 v24, 16, v161
    v_and_b32 v25, 0xffff0000, v161
    v_mul_f32 v24, v24, v18
    v_mul_f32 v25, v25, v19
    v_cvt_pk_bf16_f32 v24, v24, v25
    v_lshlrev_b32 v25, 16, v24
    v_and_b32 v24, 0xffff0000, v24
    v_add_f32 v216, v216, v24
    v_add_f32 v216, v216, v25
    v_lshlrev_b32 v24, 16, v162
    v_and_b32 v25, 0xffff0000, v162
    v_mul_f32 v24, v24, v20
    v_mul_f32 v25, v25, v21
    v_cvt_pk_bf16_f32 v24, v24, v25
    v_lshlrev_b32 v25, 16, v24
    v_and_b32 v24, 0xffff0000, v24
    v_add_f32 v216, v216, v24
    v_add_f32 v216, v216, v25
    v_lshlrev_b32 v24, 16, v163
    v_and_b32 v25, 0xffff0000, v163
    v_mul_f32 v24, v24, v22
    v_mul_f32 v25, v25, v23
    v_cvt_pk_bf16_f32 v24, v24, v25
    v_lshlrev_b32 v25, 16, v24
    v_and_b32 v24, 0xffff0000, v24
    v_add_f32 v216, v216, v24
    v_add_f32 v216, v216, v25
    s_waitcnt vmcnt(6)
    v_lshlrev_b32 v24, 16, v164
    v_and_b32 v25, 0xffff0000, v164
    v_mul_f32 v24, v24, v16
    v_mul_f32 v25, v25, v17
    v_cvt_pk_bf16_f32 v24, v24, v25
    v_lshlrev_b32 v25, 16, v24
    v_and_b32 v24, 0xffff0000, v24
    v_add_f32 v217, v24, v25
    v_lshlrev_b32 v24, 16, v165
    v_and_b32 v25, 0xffff0000, v165
    v_mul_f32 v24, v24, v18
    v_mul_f32 v25, v25, v19
    v_cvt_pk_bf16_f32 v24, v24, v25
    v_lshlrev_b32 v25, 16, v24
    v_and_b32 v24, 0xffff0000, v24
    v_add_f32 v217, v217, v24
    v_add_f32 v217, v217, v25
    v_lshlrev_b32 v24, 16, v166
    v_and_b32 v25, 0xffff0000, v166
    v_mul_f32 v24, v24, v20
    v_mul_f32 v25, v25, v21
    v_cvt_pk_bf16_f32 v24, v24, v25
    v_lshlrev_b32 v25, 16, v24
    v_and_b32 v24, 0xffff0000, v24
    v_add_f32 v217, v217, v24
    v_add_f32 v217, v217, v25
    v_lshlrev_b32 v24, 16, v167
    v_and_b32 v25, 0xffff0000, v167
    v_mul_f32 v24, v24, v22
    v_mul_f32 v25, v25, v23
    v_cvt_pk_bf16_f32 v24, v24, v25
    v_lshlrev_b32 v25, 16, v24
    v_and_b32 v24, 0xffff0000, v24
    v_add_f32 v217, v217, v24
    v_add_f32 v217, v217, v25
    s_waitcnt vmcnt(5)
    v_lshlrev_b32 v24, 16, v168
    v_and_b32 v25, 0xffff0000, v168
    v_mul_f32 v24, v24, v16
    v_mul_f32 v25, v25, v17
    v_cvt_pk_bf16_f32 v24, v24, v25
    v_lshlrev_b32 v25, 16, v24
    v_and_b32 v24, 0xffff0000, v24
    v_add_f32 v218, v24, v25
    v_lshlrev_b32 v24, 16, v169
    v_and_b32 v25, 0xffff0000, v169
    v_mul_f32 v24, v24, v18
    v_mul_f32 v25, v25, v19
    v_cvt_pk_bf16_f32 v24, v24, v25
    v_lshlrev_b32 v25, 16, v24
    v_and_b32 v24, 0xffff0000, v24
    v_add_f32 v218, v218, v24
    v_add_f32 v218, v218, v25
    v_lshlrev_b32 v24, 16, v170
    v_and_b32 v25, 0xffff0000, v170
    v_mul_f32 v24, v24, v20
    v_mul_f32 v25, v25, v21
    v_cvt_pk_bf16_f32 v24, v24, v25
    v_lshlrev_b32 v25, 16, v24
    v_and_b32 v24, 0xffff0000, v24
    v_add_f32 v218, v218, v24
    v_add_f32 v218, v218, v25
    v_lshlrev_b32 v24, 16, v171
    v_and_b32 v25, 0xffff0000, v171
    v_mul_f32 v24, v24, v22
    v_mul_f32 v25, v25, v23
    v_cvt_pk_bf16_f32 v24, v24, v25
    v_lshlrev_b32 v25, 16, v24
    v_and_b32 v24, 0xffff0000, v24
    v_add_f32 v218, v218, v24
    v_add_f32 v218, v218, v25
    s_waitcnt vmcnt(4)
    v_lshlrev_b32 v24, 16, v172
    v_and_b32 v25, 0xffff0000, v172
    v_mul_f32 v24, v24, v16
    v_mul_f32 v25, v25, v17
    v_cvt_pk_bf16_f32 v24, v24, v25
    v_lshlrev_b32 v25, 16, v24
    v_and_b32 v24, 0xffff0000, v24
    v_add_f32 v219, v24, v25
    v_lshlrev_b32 v24, 16, v173
    v_and_b32 v25, 0xffff0000, v173
    v_mul_f32 v24, v24, v18
    v_mul_f32 v25, v25, v19
    v_cvt_pk_bf16_f32 v24, v24, v25
    v_lshlrev_b32 v25, 16, v24
    v_and_b32 v24, 0xffff0000, v24
    v_add_f32 v219, v219, v24
    v_add_f32 v219, v219, v25
    v_lshlrev_b32 v24, 16, v174
    v_and_b32 v25, 0xffff0000, v174
    v_mul_f32 v24, v24, v20
    v_mul_f32 v25, v25, v21
    v_cvt_pk_bf16_f32 v24, v24, v25
    v_lshlrev_b32 v25, 16, v24
    v_and_b32 v24, 0xffff0000, v24
    v_add_f32 v219, v219, v24
    v_add_f32 v219, v219, v25
    v_lshlrev_b32 v24, 16, v175
    v_and_b32 v25, 0xffff0000, v175
    v_mul_f32 v24, v24, v22
    v_mul_f32 v25, v25, v23
    v_cvt_pk_bf16_f32 v24, v24, v25
    v_lshlrev_b32 v25, 16, v24
    v_and_b32 v24, 0xffff0000, v24
    v_add_f32 v219, v219, v24
    v_add_f32 v219, v219, v25
    s_waitcnt vmcnt(3)
    v_lshlrev_b32 v24, 16, v176
    v_and_b32 v25, 0xffff0000, v176
    v_mul_f32 v24, v24, v16
    v_mul_f32 v25, v25, v17
    v_cvt_pk_bf16_f32 v24, v24, v25
    v_lshlrev_b32 v25, 16, v24
    v_and_b32 v24, 0xffff0000, v24
    v_add_f32 v220, v24, v25
    v_lshlrev_b32 v24, 16, v177
    v_and_b32 v25, 0xffff0000, v177
    v_mul_f32 v24, v24, v18
    v_mul_f32 v25, v25, v19
    v_cvt_pk_bf16_f32 v24, v24, v25
    v_lshlrev_b32 v25, 16, v24
    v_and_b32 v24, 0xffff0000, v24
    v_add_f32 v220, v220, v24
    v_add_f32 v220, v220, v25
    v_lshlrev_b32 v24, 16, v178
    v_and_b32 v25, 0xffff0000, v178
    v_mul_f32 v24, v24, v20
    v_mul_f32 v25, v25, v21
    v_cvt_pk_bf16_f32 v24, v24, v25
    v_lshlrev_b32 v25, 16, v24
    v_and_b32 v24, 0xffff0000, v24
    v_add_f32 v220, v220, v24
    v_add_f32 v220, v220, v25
    v_lshlrev_b32 v24, 16, v179
    v_and_b32 v25, 0xffff0000, v179
    v_mul_f32 v24, v24, v22
    v_mul_f32 v25, v25, v23
    v_cvt_pk_bf16_f32 v24, v24, v25
    v_lshlrev_b32 v25, 16, v24
    v_and_b32 v24, 0xffff0000, v24
    v_add_f32 v220, v220, v24
    v_add_f32 v220, v220, v25
    s_waitcnt vmcnt(2)
    v_lshlrev_b32 v24, 16, v180
    v_and_b32 v25, 0xffff0000, v180
    v_mul_f32 v24, v24, v16
    v_mul_f32 v25, v25, v17
    v_cvt_pk_bf16_f32 v24, v24, v25
    v_lshlrev_b32 v25, 16, v24
    v_and_b32 v24, 0xffff0000, v24
    v_add_f32 v221, v24, v25
    v_lshlrev_b32 v24, 16, v181
    v_and_b32 v25, 0xffff0000, v181
    v_mul_f32 v24, v24, v18
    v_mul_f32 v25, v25, v19
    v_cvt_pk_bf16_f32 v24, v24, v25
    v_lshlrev_b32 v25, 16, v24
    v_and_b32 v24, 0xffff0000, v24
    v_add_f32 v221, v221, v24
    v_add_f32 v221, v221, v25
    v_lshlrev_b32 v24, 16, v182
    v_and_b32 v25, 0xffff0000, v182
    v_mul_f32 v24, v24, v20
    v_mul_f32 v25, v25, v21
    v_cvt_pk_bf16_f32 v24, v24, v25
    v_lshlrev_b32 v25, 16, v24
    v_and_b32 v24, 0xffff0000, v24
    v_add_f32 v221, v221, v24
    v_add_f32 v221, v221, v25
    v_lshlrev_b32 v24, 16, v183
    v_and_b32 v25, 0xffff0000, v183
    v_mul_f32 v24, v24, v22
    v_mul_f32 v25, v25, v23
    v_cvt_pk_bf16_f32 v24, v24, v25
    v_lshlrev_b32 v25, 16, v24
    v_and_b32 v24, 0xffff0000, v24
    v_add_f32 v221, v221, v24
    v_add_f32 v221, v221, v25
    s_waitcnt vmcnt(1)
    v_lshlrev_b32 v24, 16, v184
    v_and_b32 v25, 0xffff0000, v184
    v_mul_f32 v24, v24, v16
    v_mul_f32 v25, v25, v17
    v_cvt_pk_bf16_f32 v24, v24, v25
    v_lshlrev_b32 v25, 16, v24
    v_and_b32 v24, 0xffff0000, v24
    v_add_f32 v222, v24, v25
    v_lshlrev_b32 v24, 16, v185
    v_and_b32 v25, 0xffff0000, v185
    v_mul_f32 v24, v24, v18
    v_mul_f32 v25, v25, v19
    v_cvt_pk_bf16_f32 v24, v24, v25
    v_lshlrev_b32 v25, 16, v24
    v_and_b32 v24, 0xffff0000, v24
    v_add_f32 v222, v222, v24
    v_add_f32 v222, v222, v25
    v_lshlrev_b32 v24, 16, v186
    v_and_b32 v25, 0xffff0000, v186
    v_mul_f32 v24, v24, v20
    v_mul_f32 v25, v25, v21
    v_cvt_pk_bf16_f32 v24, v24, v25
    v_lshlrev_b32 v25, 16, v24
    v_and_b32 v24, 0xffff0000, v24
    v_add_f32 v222, v222, v24
    v_add_f32 v222, v222, v25
    v_lshlrev_b32 v24, 16, v187
    v_and_b32 v25, 0xffff0000, v187
    v_mul_f32 v24, v24, v22
    v_mul_f32 v25, v25, v23
    v_cvt_pk_bf16_f32 v24, v24, v25
    v_lshlrev_b32 v25, 16, v24
    v_and_b32 v24, 0xffff0000, v24
    v_add_f32 v222, v222, v24
    v_add_f32 v222, v222, v25
    s_waitcnt vmcnt(0)
    v_lshlrev_b32 v24, 16, v188
    v_and_b32 v25, 0xffff0000, v188
    v_mul_f32 v24, v24, v16
    v_mul_f32 v25, v25, v17
    v_cvt_pk_bf16_f32 v24, v24, v25
    v_lshlrev_b32 v25, 16, v24
    v_and_b32 v24, 0xffff0000, v24
    v_add_f32 v223, v24, v25
    v_lshlrev_b32 v24, 16, v189
    v_and_b32 v25, 0xffff0000, v189
    v_mul_f32 v24, v24, v18
    v_mul_f32 v25, v25, v19
    v_cvt_pk_bf16_f32 v24, v24, v25
    v_lshlrev_b32 v25, 16, v24
    v_and_b32 v24, 0xffff0000, v24
    v_add_f32 v223, v223, v24
    v_add_f32 v223, v223, v25
    v_lshlrev_b32 v24, 16, v190
    v_and_b32 v25, 0xffff0000, v190
    v_mul_f32 v24, v24, v20
    v_mul_f32 v25, v25, v21
    v_cvt_pk_bf16_f32 v24, v24, v25
    v_lshlrev_b32 v25, 16, v24
    v_and_b32 v24, 0xffff0000, v24
    v_add_f32 v223, v223, v24
    v_add_f32 v223, v223, v25
    v_lshlrev_b32 v24, 16, v191
    v_and_b32 v25, 0xffff0000, v191
    v_mul_f32 v24, v24, v22
    v_mul_f32 v25, v25, v23
    v_cvt_pk_bf16_f32 v24, v24, v25
    v_lshlrev_b32 v25, 16, v24
    v_and_b32 v24, 0xffff0000, v24
    v_add_f32 v223, v223, v24
    v_add_f32 v223, v223, v25
    ds_swizzle_b32 v64, v192 offset:0x41f
    ds_swizzle_b32 v65, v193 offset:0x41f
    ds_swizzle_b32 v66, v194 offset:0x41f
    ds_swizzle_b32 v67, v195 offset:0x41f
    ds_swizzle_b32 v68, v196 offset:0x41f
    ds_swizzle_b32 v69, v197 offset:0x41f
    ds_swizzle_b32 v70, v198 offset:0x41f
    ds_swizzle_b32 v71, v199 offset:0x41f
    ds_swizzle_b32 v72, v200 offset:0x41f
    ds_swizzle_b32 v73, v201 offset:0x41f
    ds_swizzle_b32 v74, v202 offset:0x41f
    ds_swizzle_b32 v75, v203 offset:0x41f
    ds_swizzle_b32 v76, v204 offset:0x41f
    ds_swizzle_b32 v77, v205 offset:0x41f
    ds_swizzle_b32 v78, v206 offset:0x41f
    ds_swizzle_b32 v79, v207 offset:0x41f
    ds_swizzle_b32 v80, v208 offset:0x41f
    ds_swizzle_b32 v81, v209 offset:0x41f
    ds_swizzle_b32 v82, v210 offset:0x41f
    ds_swizzle_b32 v83, v211 offset:0x41f
    ds_swizzle_b32 v84, v212 offset:0x41f
    ds_swizzle_b32 v85, v213 offset:0x41f
    ds_swizzle_b32 v86, v214 offset:0x41f
    ds_swizzle_b32 v87, v215 offset:0x41f
    ds_swizzle_b32 v88, v216 offset:0x41f
    ds_swizzle_b32 v89, v217 offset:0x41f
    ds_swizzle_b32 v90, v218 offset:0x41f
    ds_swizzle_b32 v91, v219 offset:0x41f
    ds_swizzle_b32 v92, v220 offset:0x41f
    ds_swizzle_b32 v93, v221 offset:0x41f
    ds_swizzle_b32 v94, v222 offset:0x41f
    ds_swizzle_b32 v95, v223 offset:0x41f
    s_waitcnt lgkmcnt(0)
    v_add_f32 v192, v192, v64
    v_add_f32 v193, v193, v65
    v_add_f32 v194, v194, v66
    v_add_f32 v195, v195, v67
    v_add_f32 v196, v196, v68
    v_add_f32 v197, v197, v69
    v_add_f32 v198, v198, v70
    v_add_f32 v199, v199, v71
    v_add_f32 v200, v200, v72
    v_add_f32 v201, v201, v73
    v_add_f32 v202, v202, v74
    v_add_f32 v203, v203, v75
    v_add_f32 v204, v204, v76
    v_add_f32 v205, v205, v77
    v_add_f32 v206, v206, v78
    v_add_f32 v207, v207, v79
    v_add_f32 v208, v208, v80
    v_add_f32 v209, v209, v81
    v_add_f32 v210, v210, v82
    v_add_f32 v211, v211, v83
    v_add_f32 v212, v212, v84
    v_add_f32 v213, v213, v85
    v_add_f32 v214, v214, v86
    v_add_f32 v215, v215, v87
    v_add_f32 v216, v216, v88
    v_add_f32 v217, v217, v89
    v_add_f32 v218, v218, v90
    v_add_f32 v219, v219, v91
    v_add_f32 v220, v220, v92
    v_add_f32 v221, v221, v93
    v_add_f32 v222, v222, v94
    v_add_f32 v223, v223, v95
    ds_swizzle_b32 v64, v192 offset:0x81f
    ds_swizzle_b32 v65, v193 offset:0x81f
    ds_swizzle_b32 v66, v194 offset:0x81f
    ds_swizzle_b32 v67, v195 offset:0x81f
    ds_swizzle_b32 v68, v196 offset:0x81f
    ds_swizzle_b32 v69, v197 offset:0x81f
    ds_swizzle_b32 v70, v198 offset:0x81f
    ds_swizzle_b32 v71, v199 offset:0x81f
    ds_swizzle_b32 v72, v200 offset:0x81f
    ds_swizzle_b32 v73, v201 offset:0x81f
    ds_swizzle_b32 v74, v202 offset:0x81f
    ds_swizzle_b32 v75, v203 offset:0x81f
    ds_swizzle_b32 v76, v204 offset:0x81f
    ds_swizzle_b32 v77, v205 offset:0x81f
    ds_swizzle_b32 v78, v206 offset:0x81f
    ds_swizzle_b32 v79, v207 offset:0x81f
    ds_swizzle_b32 v80, v208 offset:0x81f
    ds_swizzle_b32 v81, v209 offset:0x81f
    ds_swizzle_b32 v82, v210 offset:0x81f
    ds_swizzle_b32 v83, v211 offset:0x81f
    ds_swizzle_b32 v84, v212 offset:0x81f
    ds_swizzle_b32 v85, v213 offset:0x81f
    ds_swizzle_b32 v86, v214 offset:0x81f
    ds_swizzle_b32 v87, v215 offset:0x81f
    ds_swizzle_b32 v88, v216 offset:0x81f
    ds_swizzle_b32 v89, v217 offset:0x81f
    ds_swizzle_b32 v90, v218 offset:0x81f
    ds_swizzle_b32 v91, v219 offset:0x81f
    ds_swizzle_b32 v92, v220 offset:0x81f
    ds_swizzle_b32 v93, v221 offset:0x81f
    ds_swizzle_b32 v94, v222 offset:0x81f
    ds_swizzle_b32 v95, v223 offset:0x81f
    s_waitcnt lgkmcnt(0)
    v_add_f32 v192, v192, v64
    v_add_f32 v193, v193, v65
    v_add_f32 v194, v194, v66
    v_add_f32 v195, v195, v67
    v_add_f32 v196, v196, v68
    v_add_f32 v197, v197, v69
    v_add_f32 v198, v198, v70
    v_add_f32 v199, v199, v71
    v_add_f32 v200, v200, v72
    v_add_f32 v201, v201, v73
    v_add_f32 v202, v202, v74
    v_add_f32 v203, v203, v75
    v_add_f32 v204, v204, v76
    v_add_f32 v205, v205, v77
    v_add_f32 v206, v206, v78
    v_add_f32 v207, v207, v79
    v_add_f32 v208, v208, v80
    v_add_f32 v209, v209, v81
    v_add_f32 v210, v210, v82
    v_add_f32 v211, v211, v83
    v_add_f32 v212, v212, v84
    v_add_f32 v213, v213, v85
    v_add_f32 v214, v214, v86
    v_add_f32 v215, v215, v87
    v_add_f32 v216, v216, v88
    v_add_f32 v217, v217, v89
    v_add_f32 v218, v218, v90
    v_add_f32 v219, v219, v91
    v_add_f32 v220, v220, v92
    v_add_f32 v221, v221, v93
    v_add_f32 v222, v222, v94
    v_add_f32 v223, v223, v95
    ds_swizzle_b32 v64, v192 offset:0x101f
    ds_swizzle_b32 v65, v193 offset:0x101f
    ds_swizzle_b32 v66, v194 offset:0x101f
    ds_swizzle_b32 v67, v195 offset:0x101f
    ds_swizzle_b32 v68, v196 offset:0x101f
    ds_swizzle_b32 v69, v197 offset:0x101f
    ds_swizzle_b32 v70, v198 offset:0x101f
    ds_swizzle_b32 v71, v199 offset:0x101f
    ds_swizzle_b32 v72, v200 offset:0x101f
    ds_swizzle_b32 v73, v201 offset:0x101f
    ds_swizzle_b32 v74, v202 offset:0x101f
    ds_swizzle_b32 v75, v203 offset:0x101f
    ds_swizzle_b32 v76, v204 offset:0x101f
    ds_swizzle_b32 v77, v205 offset:0x101f
    ds_swizzle_b32 v78, v206 offset:0x101f
    ds_swizzle_b32 v79, v207 offset:0x101f
    ds_swizzle_b32 v80, v208 offset:0x101f
    ds_swizzle_b32 v81, v209 offset:0x101f
    ds_swizzle_b32 v82, v210 offset:0x101f
    ds_swizzle_b32 v83, v211 offset:0x101f
    ds_swizzle_b32 v84, v212 offset:0x101f
    ds_swizzle_b32 v85, v213 offset:0x101f
    ds_swizzle_b32 v86, v214 offset:0x101f
    ds_swizzle_b32 v87, v215 offset:0x101f
    ds_swizzle_b32 v88, v216 offset:0x101f
    ds_swizzle_b32 v89, v217 offset:0x101f
    ds_swizzle_b32 v90, v218 offset:0x101f
    ds_swizzle_b32 v91, v219 offset:0x101f
    ds_swizzle_b32 v92, v220 offset:0x101f
    ds_swizzle_b32 v93, v221 offset:0x101f
    ds_swizzle_b32 v94, v222 offset:0x101f
    ds_swizzle_b32 v95, v223 offset:0x101f
    s_waitcnt lgkmcnt(0)
    v_add_f32 v192, v192, v64
    v_add_f32 v193, v193, v65
    v_add_f32 v194, v194, v66
    v_add_f32 v195, v195, v67
    v_add_f32 v196, v196, v68
    v_add_f32 v197, v197, v69
    v_add_f32 v198, v198, v70
    v_add_f32 v199, v199, v71
    v_add_f32 v200, v200, v72
    v_add_f32 v201, v201, v73
    v_add_f32 v202, v202, v74
    v_add_f32 v203, v203, v75
    v_add_f32 v204, v204, v76
    v_add_f32 v205, v205, v77
    v_add_f32 v206, v206, v78
    v_add_f32 v207, v207, v79
    v_add_f32 v208, v208, v80
    v_add_f32 v209, v209, v81
    v_add_f32 v210, v210, v82
    v_add_f32 v211, v211, v83
    v_add_f32 v212, v212, v84
    v_add_f32 v213, v213, v85
    v_add_f32 v214, v214, v86
    v_add_f32 v215, v215, v87
    v_add_f32 v216, v216, v88
    v_add_f32 v217, v217, v89
    v_add_f32 v218, v218, v90
    v_add_f32 v219, v219, v91
    v_add_f32 v220, v220, v92
    v_add_f32 v221, v221, v93
    v_add_f32 v222, v222, v94
    v_add_f32 v223, v223, v95
    ds_swizzle_b32 v64, v192 offset:0x201f
    ds_swizzle_b32 v65, v193 offset:0x201f
    ds_swizzle_b32 v66, v194 offset:0x201f
    ds_swizzle_b32 v67, v195 offset:0x201f
    ds_swizzle_b32 v68, v196 offset:0x201f
    ds_swizzle_b32 v69, v197 offset:0x201f
    ds_swizzle_b32 v70, v198 offset:0x201f
    ds_swizzle_b32 v71, v199 offset:0x201f
    ds_swizzle_b32 v72, v200 offset:0x201f
    ds_swizzle_b32 v73, v201 offset:0x201f
    ds_swizzle_b32 v74, v202 offset:0x201f
    ds_swizzle_b32 v75, v203 offset:0x201f
    ds_swizzle_b32 v76, v204 offset:0x201f
    ds_swizzle_b32 v77, v205 offset:0x201f
    ds_swizzle_b32 v78, v206 offset:0x201f
    ds_swizzle_b32 v79, v207 offset:0x201f
    ds_swizzle_b32 v80, v208 offset:0x201f
    ds_swizzle_b32 v81, v209 offset:0x201f
    ds_swizzle_b32 v82, v210 offset:0x201f
    ds_swizzle_b32 v83, v211 offset:0x201f
    ds_swizzle_b32 v84, v212 offset:0x201f
    ds_swizzle_b32 v85, v213 offset:0x201f
    ds_swizzle_b32 v86, v214 offset:0x201f
    ds_swizzle_b32 v87, v215 offset:0x201f
    ds_swizzle_b32 v88, v216 offset:0x201f
    ds_swizzle_b32 v89, v217 offset:0x201f
    ds_swizzle_b32 v90, v218 offset:0x201f
    ds_swizzle_b32 v91, v219 offset:0x201f
    ds_swizzle_b32 v92, v220 offset:0x201f
    ds_swizzle_b32 v93, v221 offset:0x201f
    ds_swizzle_b32 v94, v222 offset:0x201f
    ds_swizzle_b32 v95, v223 offset:0x201f
    s_waitcnt lgkmcnt(0)
    v_add_f32 v192, v192, v64
    v_add_f32 v193, v193, v65
    v_add_f32 v194, v194, v66
    v_add_f32 v195, v195, v67
    v_add_f32 v196, v196, v68
    v_add_f32 v197, v197, v69
    v_add_f32 v198, v198, v70
    v_add_f32 v199, v199, v71
    v_add_f32 v200, v200, v72
    v_add_f32 v201, v201, v73
    v_add_f32 v202, v202, v74
    v_add_f32 v203, v203, v75
    v_add_f32 v204, v204, v76
    v_add_f32 v205, v205, v77
    v_add_f32 v206, v206, v78
    v_add_f32 v207, v207, v79
    v_add_f32 v208, v208, v80
    v_add_f32 v209, v209, v81
    v_add_f32 v210, v210, v82
    v_add_f32 v211, v211, v83
    v_add_f32 v212, v212, v84
    v_add_f32 v213, v213, v85
    v_add_f32 v214, v214, v86
    v_add_f32 v215, v215, v87
    v_add_f32 v216, v216, v88
    v_add_f32 v217, v217, v89
    v_add_f32 v218, v218, v90
    v_add_f32 v219, v219, v91
    v_add_f32 v220, v220, v92
    v_add_f32 v221, v221, v93
    v_add_f32 v222, v222, v94
    v_add_f32 v223, v223, v95
    ds_swizzle_b32 v64, v192 offset:0x401f
    ds_swizzle_b32 v65, v193 offset:0x401f
    ds_swizzle_b32 v66, v194 offset:0x401f
    ds_swizzle_b32 v67, v195 offset:0x401f
    ds_swizzle_b32 v68, v196 offset:0x401f
    ds_swizzle_b32 v69, v197 offset:0x401f
    ds_swizzle_b32 v70, v198 offset:0x401f
    ds_swizzle_b32 v71, v199 offset:0x401f
    ds_swizzle_b32 v72, v200 offset:0x401f
    ds_swizzle_b32 v73, v201 offset:0x401f
    ds_swizzle_b32 v74, v202 offset:0x401f
    ds_swizzle_b32 v75, v203 offset:0x401f
    ds_swizzle_b32 v76, v204 offset:0x401f
    ds_swizzle_b32 v77, v205 offset:0x401f
    ds_swizzle_b32 v78, v206 offset:0x401f
    ds_swizzle_b32 v79, v207 offset:0x401f
    ds_swizzle_b32 v80, v208 offset:0x401f
    ds_swizzle_b32 v81, v209 offset:0x401f
    ds_swizzle_b32 v82, v210 offset:0x401f
    ds_swizzle_b32 v83, v211 offset:0x401f
    ds_swizzle_b32 v84, v212 offset:0x401f
    ds_swizzle_b32 v85, v213 offset:0x401f
    ds_swizzle_b32 v86, v214 offset:0x401f
    ds_swizzle_b32 v87, v215 offset:0x401f
    ds_swizzle_b32 v88, v216 offset:0x401f
    ds_swizzle_b32 v89, v217 offset:0x401f
    ds_swizzle_b32 v90, v218 offset:0x401f
    ds_swizzle_b32 v91, v219 offset:0x401f
    ds_swizzle_b32 v92, v220 offset:0x401f
    ds_swizzle_b32 v93, v221 offset:0x401f
    ds_swizzle_b32 v94, v222 offset:0x401f
    ds_swizzle_b32 v95, v223 offset:0x401f
    s_waitcnt lgkmcnt(0)
    v_add_f32 v192, v192, v64
    v_add_f32 v193, v193, v65
    v_add_f32 v194, v194, v66
    v_add_f32 v195, v195, v67
    v_add_f32 v196, v196, v68
    v_add_f32 v197, v197, v69
    v_add_f32 v198, v198, v70
    v_add_f32 v199, v199, v71
    v_add_f32 v200, v200, v72
    v_add_f32 v201, v201, v73
    v_add_f32 v202, v202, v74
    v_add_f32 v203, v203, v75
    v_add_f32 v204, v204, v76
    v_add_f32 v205, v205, v77
    v_add_f32 v206, v206, v78
    v_add_f32 v207, v207, v79
    v_add_f32 v208, v208, v80
    v_add_f32 v209, v209, v81
    v_add_f32 v210, v210, v82
    v_add_f32 v211, v211, v83
    v_add_f32 v212, v212, v84
    v_add_f32 v213, v213, v85
    v_add_f32 v214, v214, v86
    v_add_f32 v215, v215, v87
    v_add_f32 v216, v216, v88
    v_add_f32 v217, v217, v89
    v_add_f32 v218, v218, v90
    v_add_f32 v219, v219, v91
    v_add_f32 v220, v220, v92
    v_add_f32 v221, v221, v93
    v_add_f32 v222, v222, v94
    v_add_f32 v223, v223, v95
    v_xor_b32 v26, 32, v1
    v_lshlrev_b32 v26, 2, v26
    ds_bpermute_b32 v64, v26, v192
    ds_bpermute_b32 v65, v26, v193
    ds_bpermute_b32 v66, v26, v194
    ds_bpermute_b32 v67, v26, v195
    ds_bpermute_b32 v68, v26, v196
    ds_bpermute_b32 v69, v26, v197
    ds_bpermute_b32 v70, v26, v198
    ds_bpermute_b32 v71, v26, v199
    ds_bpermute_b32 v72, v26, v200
    ds_bpermute_b32 v73, v26, v201
    ds_bpermute_b32 v74, v26, v202
    ds_bpermute_b32 v75, v26, v203
    ds_bpermute_b32 v76, v26, v204
    ds_bpermute_b32 v77, v26, v205
    ds_bpermute_b32 v78, v26, v206
    ds_bpermute_b32 v79, v26, v207
    ds_bpermute_b32 v80, v26, v208
    ds_bpermute_b32 v81, v26, v209
    ds_bpermute_b32 v82, v26, v210
    ds_bpermute_b32 v83, v26, v211
    ds_bpermute_b32 v84, v26, v212
    ds_bpermute_b32 v85, v26, v213
    ds_bpermute_b32 v86, v26, v214
    ds_bpermute_b32 v87, v26, v215
    ds_bpermute_b32 v88, v26, v216
    ds_bpermute_b32 v89, v26, v217
    ds_bpermute_b32 v90, v26, v218
    ds_bpermute_b32 v91, v26, v219
    ds_bpermute_b32 v92, v26, v220
    ds_bpermute_b32 v93, v26, v221
    ds_bpermute_b32 v94, v26, v222
    ds_bpermute_b32 v95, v26, v223
    s_waitcnt lgkmcnt(0)
    v_mov_b32 v27, 0
    v_add_f32 v192, v192, v64
    v_cmp_eq_u32 vcc, 0, v1
    s_nop 1
    v_cndmask_b32 v27, v27, v192, vcc
    v_add_f32 v193, v193, v65
    v_cmp_eq_u32 vcc, 1, v1
    s_nop 1
    v_cndmask_b32 v27, v27, v193, vcc
    v_add_f32 v194, v194, v66
    v_cmp_eq_u32 vcc, 2, v1
    s_nop 1
    v_cndmask_b32 v27, v27, v194, vcc
    v_add_f32 v195, v195, v67
    v_cmp_eq_u32 vcc, 3, v1
    s_nop 1
    v_cndmask_b32 v27, v27, v195, vcc
    v_add_f32 v196, v196, v68
    v_cmp_eq_u32 vcc, 4, v1
    s_nop 1
    v_cndmask_b32 v27, v27, v196, vcc
    v_add_f32 v197, v197, v69
    v_cmp_eq_u32 vcc, 5, v1
    s_nop 1
    v_cndmask_b32 v27, v27, v197, vcc
    v_add_f32 v198, v198, v70
    v_cmp_eq_u32 vcc, 6, v1
    s_nop 1
    v_cndmask_b32 v27, v27, v198, vcc
    v_add_f32 v199, v199, v71
    v_cmp_eq_u32 vcc, 7, v1
    s_nop 1
    v_cndmask_b32 v27, v27, v199, vcc
    v_add_f32 v200, v200, v72
    v_cmp_eq_u32 vcc, 8, v1
    s_nop 1
    v_cndmask_b32 v27, v27, v200, vcc
    v_add_f32 v201, v201, v73
    v_cmp_eq_u32 vcc, 9, v1
    s_nop 1
    v_cndmask_b32 v27, v27, v201, vcc
    v_add_f32 v202, v202, v74
    v_cmp_eq_u32 vcc, 10, v1
    s_nop 1
    v_cndmask_b32 v27, v27, v202, vcc
    v_add_f32 v203, v203, v75
    v_cmp_eq_u32 vcc, 11, v1
    s_nop 1
    v_cndmask_b32 v27, v27, v203, vcc
    v_add_f32 v204, v204, v76
    v_cmp_eq_u32 vcc, 12, v1
    s_nop 1
    v_cndmask_b32 v27, v27, v204, vcc
    v_add_f32 v205, v205, v77
    v_cmp_eq_u32 vcc, 13, v1
    s_nop 1
    v_cndmask_b32 v27, v27, v205, vcc
    v_add_f32 v206, v206, v78
    v_cmp_eq_u32 vcc, 14, v1
    s_nop 1
    v_cndmask_b32 v27, v27, v206, vcc
    v_add_f32 v207, v207, v79
    v_cmp_eq_u32 vcc, 15, v1
    s_nop 1
    v_cndmask_b32 v27, v27, v207, vcc
    v_add_f32 v208, v208, v80
    v_cmp_eq_u32 vcc, 16, v1
    s_nop 1
    v_cndmask_b32 v27, v27, v208, vcc
    v_add_f32 v209, v209, v81
    v_cmp_eq_u32 vcc, 17, v1
    s_nop 1
    v_cndmask_b32 v27, v27, v209, vcc
    v_add_f32 v210, v210, v82
    v_cmp_eq_u32 vcc, 18, v1
    s_nop 1
    v_cndmask_b32 v27, v27, v210, vcc
    v_add_f32 v211, v211, v83
    v_cmp_eq_u32 vcc, 19, v1
    s_nop 1
    v_cndmask_b32 v27, v27, v211, vcc
    v_add_f32 v212, v212, v84
    v_cmp_eq_u32 vcc, 20, v1
    s_nop 1
    v_cndmask_b32 v27, v27, v212, vcc
    v_add_f32 v213, v213, v85
    v_cmp_eq_u32 vcc, 21, v1
    s_nop 1
    v_cndmask_b32 v27, v27, v213, vcc
    v_add_f32 v214, v214, v86
    v_cmp_eq_u32 vcc, 22, v1
    s_nop 1
    v_cndmask_b32 v27, v27, v214, vcc
    v_add_f32 v215, v215, v87
    v_cmp_eq_u32 vcc, 23, v1
    s_nop 1
    v_cndmask_b32 v27, v27, v215, vcc
    v_add_f32 v216, v216, v88
    v_cmp_eq_u32 vcc, 24, v1
    s_nop 1
    v_cndmask_b32 v27, v27, v216, vcc
    v_add_f32 v217, v217, v89
    v_cmp_eq_u32 vcc, 25, v1
    s_nop 1
    v_cndmask_b32 v27, v27, v217, vcc
    v_add_f32 v218, v218, v90
    v_cmp_eq_u32 vcc, 26, v1
    s_nop 1
    v_cndmask_b32 v27, v27, v218, vcc
    v_add_f32 v219, v219, v91
    v_cmp_eq_u32 vcc, 27, v1
    s_nop 1
    v_cndmask_b32 v27, v27, v219, vcc
    v_add_f32 v220, v220, v92
    v_cmp_eq_u32 vcc, 28, v1
    s_nop 1
    v_cndmask_b32 v27, v27, v220, vcc
    v_add_f32 v221, v221, v93
    v_cmp_eq_u32 vcc, 29, v1
    s_nop 1
    v_cndmask_b32 v27, v27, v221, vcc
    v_add_f32 v222, v222, v94
    v_cmp_eq_u32 vcc, 30, v1
    s_nop 1
    v_cndmask_b32 v27, v27, v222, vcc
    v_add_f32 v223, v223, v95
    v_cmp_eq_u32 vcc, 31, v1
    s_nop 1
    v_cndmask_b32 v27, v27, v223, vcc
    v_cvt_pk_bf16_f32 v27, v27, v27
    v_lshlrev_b32 v27, 16, v27
    v_mul_f32 v27, 0xbfb8aa3b, v27
    v_exp_f32 v27, v27
    s_nop 0
    v_add_f32 v27, 1.0, v27
    v_rcp_f32 v27, v27
    s_nop 0
    v_cvt_pk_bf16_f32 v27, v27, v27
    v_lshlrev_b32 v27, 16, v27
    s_lshl_b32 s9, s8, 2
    s_add_u32 s9, s9, 8388608
    v_lshlrev_b32 v28, 2, v1
    v_add_u32 v28, s9, v28
    v_cmp_gt_u32 vcc, 32, v1
    s_nop 1
    s_and_saveexec_b64 s[72:73], vcc
    buffer_store_dword v27, v28, s[52:55], 0 offen
    s_mov_b64 exec, s[72:73]
    s_endpgm
L_k1_exit:
    s_endpgm

.globl gm_stage2_kernel
.p2align 8
.type gm_stage2_kernel,@function
gm_stage2_kernel:
    s_cmp_ge_u32 s2, 256
    s_cbranch_scc1 L_k2_exit
    s_load_dwordx2 s[44:45], s[0:1], 112
    s_load_dwordx2 s[40:41], s[0:1], 96
    s_and_b32 s4, s2, 7
    s_lshl_b32 s4, s4, 2
    s_bfe_u32 s5, s2, 0x20003
    s_add_u32 s4, s4, s5
    s_lshr_b32 s5, s2, 5
    v_and_b32 v1, 63, v0
    v_lshrrev_b32 v2, 6, v0
    s_nop 0
    v_readfirstlane_b32 s7, v2
    s_nop 1
    s_and_b32 s12, s7, 1
    s_lshr_b32 s13, s7, 1
    s_lshl_b32 s8, s5, 1
    s_add_u32 s8, s8, s13
    s_mul_i32 s8, s8, 88
    s_lshl_b32 s9, s12, 2
    s_add_u32 s8, s8, s9
    s_lshl_b32 s8, s8, 10
    s_add_u32 s8, s8, 10485760
    v_lshlrev_b32 v5, 4, v1
    v_add_u32 v5, s8, v5
    v_add_u32 v6, 0x400, v5
    v_add_u32 v7, 0x800, v5
    v_add_u32 v8, 0xc00, v5
    s_lshl_b32 s14, s13, 13
    s_lshl_b32 s9, s12, 12
    s_add_u32 s14, s14, s9
    s_lshl_b32 s8, s4, 1
    s_add_u32 s8, s8, s12
    s_mul_i32 s8, s8, 88064
    s_mul_i32 s9, s13, 43*1024
    s_add_u32 s8, s8, s9
    v_lshlrev_b32 v4, 4, v1
    v_add_u32 v4, s8, v4
    v_and_b32 v2, 31, v1
    v_lshrrev_b32 v3, 5, v1
    s_lshl_b32 s8, s4, 6
    s_lshl_b32 s9, s12, 5
    s_add_u32 s15, s8, s9
    s_lshl_b32 s9, s5, 6
    s_lshl_b32 s10, s13, 5
    s_add_u32 s9, s9, s10
    v_lshlrev_b32 v9, 4, v3
    s_lshl_b32 s10, s15, 2
    s_add_u32 s10, s10, 8388608
    v_add_u32 v9, s10, v9
    v_add_u32 v10, s9, v2
    v_lshlrev_b32 v11, 6, v2
    v_lshl_add_u32 v11, v3, 5, v11
    s_lshl_b32 s10, s15, 10
    s_lshl_b32 s11, s9, 6
    s_add_u32 s10, s10, s11
    s_add_u32 s10, s10, 6291456
    v_add_u32 v11, s10, v11
    v_lshrrev_b32 v12, 5, v1
    v_lshlrev_b32 v12, 10, v12
    v_bfe_u32 v13, v1, 2, 2
    v_lshl_add_u32 v12, v13, 6, v12
    v_bfe_u32 v13, v1, 4, 1
    v_lshl_add_u32 v12, v13, 5, v12
    v_and_b32 v13, 3, v1
    v_lshl_add_u32 v12, v13, 3, v12
    s_lshl_b32 s8, s13, 13
    v_add_u32 v12, s8, v12
    v_add_u32 v13, 0x10000, v12
    s_waitcnt lgkmcnt(0)
    s_mov_b32 s52, s44
    s_and_b32 s53, s45, 0xffff
    s_mov_b32 s54, 268435456
    s_mov_b32 s55, 0x00020000
    s_add_u32 m0, s14, 0
    s_mov_b32 s8, 0
    buffer_load_dwordx4 v5, s[52:55], s8 offen lds
    s_add_u32 m0, s14, 1024
    s_mov_b32 s8, 0
    buffer_load_dwordx4 v6, s[52:55], s8 offen lds
    s_add_u32 m0, s14, 2048
    s_mov_b32 s8, 0
    buffer_load_dwordx4 v7, s[52:55], s8 offen lds
    s_add_u32 m0, s14, 3072
    s_mov_b32 s8, 0
    buffer_load_dwordx4 v8, s[52:55], s8 offen lds
    s_mov_b32 s9, 0
    buffer_load_dwordx4 v[96:99], v4, s[52:55], s9 offen offset:0
    buffer_load_dwordx4 v[100:103], v4, s[52:55], s9 offen offset:1024
    buffer_load_dwordx4 v[104:107], v4, s[52:55], s9 offen offset:2048
    buffer_load_dwordx4 v[108:111], v4, s[52:55], s9 offen offset:3072
    s_add_u32 m0, s14, 16384
    s_mov_b32 s8, 8192
    buffer_load_dwordx4 v5, s[52:55], s8 offen lds
    s_add_u32 m0, s14, 17408
    s_mov_b32 s8, 8192
    buffer_load_dwordx4 v6, s[52:55], s8 offen lds
    s_add_u32 m0, s14, 18432
    s_mov_b32 s8, 8192
    buffer_load_dwordx4 v7, s[52:55], s8 offen lds
    s_add_u32 m0, s14, 19456
    s_mov_b32 s8, 8192
    buffer_load_dwordx4 v8, s[52:55], s8 offen lds
    s_mov_b32 s9, 4096
    buffer_load_dwordx4 v[112:115], v4, s[52:55], s9 offen offset:0
    buffer_load_dwordx4 v[116:119], v4, s[52:55], s9 offen offset:1024
    buffer_load_dwordx4 v[120:123], v4, s[52:55], s9 offen offset:2048
    buffer_load_dwordx4 v[124:127], v4, s[52:55], s9 offen offset:3072
    s_add_u32 m0, s14, 32768
    s_mov_b32 s8, 16384
    buffer_load_dwordx4 v5, s[52:55], s8 offen lds
    s_add_u32 m0, s14, 33792
    s_mov_b32 s8, 16384
    buffer_load_dwordx4 v6, s[52:55], s8 offen lds
    s_add_u32 m0, s14, 34816
    s_mov_b32 s8, 16384
    buffer_load_dwordx4 v7, s[52:55], s8 offen lds
    s_add_u32 m0, s14, 35840
    s_mov_b32 s8, 16384
    buffer_load_dwordx4 v8, s[52:55], s8 offen lds
    s_mov_b32 s9, 8192
    buffer_load_dwordx4 v[128:131], v4, s[52:55], s9 offen offset:0
    buffer_load_dwordx4 v[132:135], v4, s[52:55], s9 offen offset:1024
    buffer_load_dwordx4 v[136:139], v4, s[52:55], s9 offen offset:2048
    buffer_load_dwordx4 v[140:143], v4, s[52:55], s9 offen offset:3072
    s_mov_b32 s60, s40
    s_and_b32 s61, s41, 0xffff
    s_mov_b32 s62, 2097152
    s_mov_b32 s63, 0x00020000
    v_mov_b32 v48, 0
    v_mov_b32 v49, 0
    v_mov_b32 v50, 0
    v_mov_b32 v51, 0
    v_mov_b32 v52, 0
    v_mov_b32 v53, 0
    v_mov_b32 v54, 0
    v_mov_b32 v55, 0
    v_mov_b32 v56, 0
    v_mov_b32 v57, 0
    v_mov_b32 v58, 0
    v_mov_b32 v59, 0
    v_mov_b32 v60, 0
    v_mov_b32 v61, 0
    v_mov_b32 v62, 0
    v_mov_b32 v63, 0
    v_mov_b32 v64, 0
    v_mov_b32 v65, 0
    v_mov_b32 v66, 0
    v_mov_b32 v67, 0
    v_mov_b32 v68, 0
    v_mov_b32 v69, 0
    v_mov_b32 v70, 0
    v_mov_b32 v71, 0
    v_mov_b32 v72, 0
    v_mov_b32 v73, 0
    v_mov_b32 v74, 0
    v_mov_b32 v75, 0
    v_mov_b32 v76, 0
    v_mov_b32 v77, 0
    v_mov_b32 v78, 0
    v_mov_b32 v79, 0
    s_waitcnt vmcnt(16)
    s_barrier
    s_add_u32 m0, s14, 49152
    s_mov_b32 s8, 24576
    buffer_load_dwordx4 v5, s[52:55], s8 offen lds
    s_add_u32 m0, s14, 50176
    s_mov_b32 s8, 24576
    buffer_load_dwordx4 v6, s[52:55], s8 offen lds
    s_add_u32 m0, s14, 51200
    s_mov_b32 s8, 24576
    buffer_load_dwordx4 v7, s[52:55], s8 offen lds
    s_add_u32 m0, s14, 52224
    s_mov_b32 s8, 24576
    buffer_load_dwordx4 v8, s[52:55], s8 offen lds
    s_mov_b32 s9, 12288
    buffer_load_dwordx4 v[144:147], v4, s[52:55], s9 offen offset:0
    buffer_load_dwordx4 v[148:151], v4, s[52:55], s9 offen offset:1024
    buffer_load_dwordx4 v[152:155], v4, s[52:55], s9 offen offset:2048
    buffer_load_dwordx4 v[156:159], v4, s[52:55], s9 offen offset:3072
    ds_read_b64_tr_b16 v[80:81], v12 offset:0
    ds_read_b64_tr_b16 v[82:83], v12 offset:512
    ds_read_b64_tr_b16 v[84:85], v12 offset:256
    ds_read_b64_tr_b16 v[86:87], v12 offset:768
    ds_read_b64_tr_b16 v[88:89], v12 offset:2048
    ds_read_b64_tr_b16 v[90:91], v12 offset:2560
    ds_read_b64_tr_b16 v[92:93], v12 offset:2304
    ds_read_b64_tr_b16 v[94:95], v12 offset:2816
    s_waitcnt lgkmcnt(4)
    v_mfma_f32_32x32x16_bf16 v[48:63], v[96:99], v[80:83], v[48:63]
    v_mfma_f32_32x32x16_bf16 v[64:79], v[96:99], v[84:87], v[64:79]
    ds_read_b64_tr_b16 v[80:81], v12 offset:4096
    ds_read_b64_tr_b16 v[82:83], v12 offset:4608
    ds_read_b64_tr_b16 v[84:85], v12 offset:4352
    ds_read_b64_tr_b16 v[86:87], v12 offset:4864
    s_waitcnt lgkmcnt(4)
    v_mfma_f32_32x32x16_bf16 v[48:63], v[100:103], v[88:91], v[48:63]
    v_mfma_f32_32x32x16_bf16 v[64:79], v[100:103], v[92:95], v[64:79]
    ds_read_b64_tr_b16 v[88:89], v12 offset:6144
    ds_read_b64_tr_b16 v[90:91], v12 offset:6656
    ds_read_b64_tr_b16 v[92:93], v12 offset:6400
    ds_read_b64_tr_b16 v[94:95], v12 offset:6912
    s_waitcnt lgkmcnt(4)
    v_mfma_f32_32x32x16_bf16 v[48:63], v[104:107], v[80:83], v[48:63]
    v_mfma_f32_32x32x16_bf16 v[64:79], v[104:107], v[84:87], v[64:79]
    s_waitcnt lgkmcnt(0)
    v_mfma_f32_32x32x16_bf16 v[48:63], v[108:111], v[88:91], v[48:63]
    v_mfma_f32_32x32x16_bf16 v[64:79], v[108:111], v[92:95], v[64:79]
    s_waitcnt vmcnt(16)
    s_barrier
    s_add_u32 m0, s14, 0
    s_mov_b32 s8, 32768
    buffer_load_dwordx4 v5, s[52:55], s8 offen lds
    s_add_u32 m0, s14, 1024
    s_mov_b32 s8, 32768
    buffer_load_dwordx4 v6, s[52:55], s8 offen lds
    s_add_u32 m0, s14, 2048
    s_mov_b32 s8, 32768
    buffer_load_dwordx4 v7, s[52:55], s8 offen lds
    s_add_u32 m0, s14, 3072
    s_mov_b32 s8, 32768
    buffer_load_dwordx4 v8, s[52:55], s8 offen lds
    s_mov_b32 s9, 16384
    buffer_load_dwordx4 v[96:99], v4, s[52:55], s9 offen offset:0
    buffer_load_dwordx4 v[100:103], v4, s[52:55], s9 offen offset:1024
    buffer_load_dwordx4 v[104:107], v4, s[52:55], s9 offen offset:2048
    buffer_load_dwordx4 v[108:111], v4, s[52:55], s9 offen offset:3072
    ds_read_b64_tr_b16 v[80:81], v12 offset:16384
    ds_read_b64_tr_b16 v[82:83], v12 offset:16896
    ds_read_b64_tr_b16 v[84:85], v12 offset:16640
    ds_read_b64_tr_b16 v[86:87], v12 offset:17152
    ds_read_b64_tr_b16 v[88:89], v12 offset:18432
    ds_read_b64_tr_b16 v[90:91], v12 offset:18944
    ds_read_b64_tr_b16 v[92:93], v12 offset:18688
    ds_read_b64_tr_b16 v[94:95], v12 offset:19200
    s_waitcnt lgkmcnt(4)
    v_mfma_f32_32x32x16_bf16 v[48:63], v[112:115], v[80:83], v[48:63]
    v_mfma_f32_32x32x16_bf16 v[64:79], v[112:115], v[84:87], v[64:79]
    ds_read_b64_tr_b16 v[80:81], v12 offset:20480
    ds_read_b64_tr_b16 v[82:83], v12 offset:20992
    ds_read_b64_tr_b16 v[84:85], v12 offset:20736
    ds_read_b64_tr_b16 v[86:87], v12 offset:21248
    s_waitcnt lgkmcnt(4)
    v_mfma_f32_32x32x16_bf16 v[48:63], v[116:119], v[88:91], v[48:63]
    v_mfma_f32_32x32x16_bf16 v[64:79], v[116:119], v[92:95], v[64:79]
    ds_read_b64_tr_b16 v[88:89], v12 offset:22528
    ds_read_b64_tr_b16 v[90:91], v12 offset:23040
    ds_read_b64_tr_b16 v[92:93], v12 offset:22784
    ds_read_b64_tr_b16 v[94:95], v12 offset:23296
    s_waitcnt lgkmcnt(4)
    v_mfma_f32_32x32x16_bf16 v[48:63], v[120:123], v[80:83], v[48:63]
    v_mfma_f32_32x32x16_bf16 v[64:79], v[120:123], v[84:87], v[64:79]
    s_waitcnt lgkmcnt(0)
    v_mfma_f32_32x32x16_bf16 v[48:63], v[124:127], v[88:91], v[48:63]
    v_mfma_f32_32x32x16_bf16 v[64:79], v[124:127], v[92:95], v[64:79]
    s_waitcnt vmcnt(16)
    s_barrier
    s_add_u32 m0, s14, 16384
    s_mov_b32 s8, 40960
    buffer_load_dwordx4 v5, s[52:55], s8 offen lds
    s_add_u32 m0, s14, 17408
    s_mov_b32 s8, 40960
    buffer_load_dwordx4 v6, s[52:55], s8 offen lds
    s_add_u32 m0, s14, 18432
    s_mov_b32 s8, 40960
    buffer_load_dwordx4 v7, s[52:55], s8 offen lds
    s_add_u32 m0, s14, 19456
    s_mov_b32 s8, 40960
    buffer_load_dwordx4 v8, s[52:55], s8 offen lds
    s_mov_b32 s9, 20480
    buffer_load_dwordx4 v[112:115], v4, s[52:55], s9 offen offset:0
    buffer_load_dwordx4 v[116:119], v4, s[52:55], s9 offen offset:1024
    buffer_load_dwordx4 v[120:123], v4, s[52:55], s9 offen offset:2048
    buffer_load_dwordx4 v[124:127], v4, s[52:55], s9 offen offset:3072
    buffer_load_dwordx4 v[16:19], v9, s[52:55], 0 offen offset:0
    buffer_load_dwordx4 v[20:23], v9, s[52:55], 0 offen offset:32
    buffer_load_dwordx4 v[24:27], v9, s[52:55], 0 offen offset:64
    buffer_load_dwordx4 v[28:31], v9, s[52:55], 0 offen offset:96
    buffer_load_dwordx4 v[32:35], v11, s[52:55], 0 offen offset:0
    buffer_load_dwordx4 v[36:39], v11, s[52:55], 0 offen offset:16
    ds_read_b64_tr_b16 v[80:81], v12 offset:32768
    ds_read_b64_tr_b16 v[82:83], v12 offset:33280
    ds_read_b64_tr_b16 v[84:85], v12 offset:33024
    ds_read_b64_tr_b16 v[86:87], v12 offset:33536
    ds_read_b64_tr_b16 v[88:89], v12 offset:34816
    ds_read_b64_tr_b16 v[90:91], v12 offset:35328
    ds_read_b64_tr_b16 v[92:93], v12 offset:35072
    ds_read_b64_tr_b16 v[94:95], v12 offset:35584
    s_waitcnt lgkmcnt(4)
    v_mfma_f32_32x32x16_bf16 v[48:63], v[128:131], v[80:83], v[48:63]
    v_mfma_f32_32x32x16_bf16 v[64:79], v[128:131], v[84:87], v[64:79]
    ds_read_b64_tr_b16 v[80:81], v12 offset:36864
    ds_read_b64_tr_b16 v[82:83], v12 offset:37376
    ds_read_b64_tr_b16 v[84:85], v12 offset:37120
    ds_read_b64_tr_b16 v[86:87], v12 offset:37632
    s_waitcnt lgkmcnt(4)
    v_mfma_f32_32x32x16_bf16 v[48:63], v[132:135], v[88:91], v[48:63]
    v_mfma_f32_32x32x16_bf16 v[64:79], v[132:135], v[92:95], v[64:79]
    ds_read_b64_tr_b16 v[88:89], v12 offset:38912
    ds_read_b64_tr_b16 v[90:91], v12 offset:39424
    ds_read_b64_tr_b16 v[92:93], v12 offset:39168
    ds_read_b64_tr_b16 v[94:95], v12 offset:39680
    s_waitcnt lgkmcnt(4)
    v_mfma_f32_32x32x16_bf16 v[48:63], v[136:139], v[80:83], v[48:63]
    v_mfma_f32_32x32x16_bf16 v[64:79], v[136:139], v[84:87], v[64:79]
    s_waitcnt lgkmcnt(0)
    v_mfma_f32_32x32x16_bf16 v[48:63], v[140:143], v[88:91], v[48:63]
    v_mfma_f32_32x32x16_bf16 v[64:79], v[140:143], v[92:95], v[64:79]
    s_waitcnt vmcnt(22)
    s_barrier
    s_add_u32 m0, s14, 32768
    s_mov_b32 s8, 49152
    buffer_load_dwordx4 v5, s[52:55], s8 offen lds
    s_add_u32 m0, s14, 33792
    s_mov_b32 s8, 49152
    buffer_load_dwordx4 v6, s[52:55], s8 offen lds
    s_add_u32 m0, s14, 34816
    s_mov_b32 s8, 49152
    buffer_load_dwordx4 v7, s[52:55], s8 offen lds
    s_add_u32 m0, s14, 35840
    s_mov_b32 s8, 49152
    buffer_load_dwordx4 v8, s[52:55], s8 offen lds
    s_mov_b32 s9, 24576
    buffer_load_dwordx4 v[128:131], v4, s[52:55], s9 offen offset:0
    buffer_load_dwordx4 v[132:135], v4, s[52:55], s9 offen offset:1024
    buffer_load_dwordx4 v[136:139], v4, s[52:55], s9 offen offset:2048
    buffer_load_dwordx4 v[140:143], v4, s[52:55], s9 offen offset:3072
    ds_read_b64_tr_b16 v[80:81], v12 offset:49152
    ds_read_b64_tr_b16 v[82:83], v12 offset:49664
    ds_read_b64_tr_b16 v[84:85], v12 offset:49408
    ds_read_b64_tr_b16 v[86:87], v12 offset:49920
    ds_read_b64_tr_b16 v[88:89], v12 offset:51200
    ds_read_b64_tr_b16 v[90:91], v12 offset:51712
    ds_read_b64_tr_b16 v[92:93], v12 offset:51456
    ds_read_b64_tr_b16 v[94:95], v12 offset:51968
    s_waitcnt lgkmcnt(4)
    v_mfma_f32_32x32x16_bf16 v[48:63], v[144:147], v[80:83], v[48:63]
    v_mfma_f32_32x32x16_bf16 v[64:79], v[144:147], v[84:87], v[64:79]
    ds_read_b64_tr_b16 v[80:81], v12 offset:53248
    ds_read_b64_tr_b16 v[82:83], v12 offset:53760
    ds_read_b64_tr_b16 v[84:85], v12 offset:53504
    ds_read_b64_tr_b16 v[86:87], v12 offset:54016
    s_waitcnt lgkmcnt(4)
    v_mfma_f32_32x32x16_bf16 v[48:63], v[148:151], v[88:91], v[48:63]
    v_mfma_f32_32x32x16_bf16 v[64:79], v[148:151], v[92:95], v[64:79]
    ds_read_b64_tr_b16 v[88:89], v12 offset:55296
    ds_read_b64_tr_b16 v[90:91], v12 offset:55808
    ds_read_b64_tr_b16 v[92:93], v12 offset:55552
    ds_read_b64_tr_b16 v[94:95], v12 offset:56064
    s_waitcnt lgkmcnt(4)
    v_mfma_f32_32x32x16_bf16 v[48:63], v[152:155], v[80:83], v[48:63]
    v_mfma_f32_32x32x16_bf16 v[64:79], v[152:155], v[84:87], v[64:79]
    s_waitcnt lgkmcnt(0)
    v_mfma_f32_32x32x16_bf16 v[48:63], v[156:159], v[88:91], v[48:63]
    v_mfma_f32_32x32x16_bf16 v[64:79], v[156:159], v[92:95], v[64:79]
    s_waitcnt vmcnt(22)
    s_barrier
    s_add_u32 m0, s14, 49152
    s_mov_b32 s8, 57344
    buffer_load_dwordx4 v5, s[52:55], s8 offen lds
    s_add_u32 m0, s14, 50176
    s_mov_b32 s8, 57344
    buffer_load_dwordx4 v6, s[52:55], s8 offen lds
    s_add_u32 m0, s14, 51200
    s_mov_b32 s8, 57344
    buffer_load_dwordx4 v7, s[52:55], s8 offen lds
    s_add_u32 m0, s14, 52224
    s_mov_b32 s8, 57344
    buffer_load_dwordx4 v8, s[52:55], s8 offen lds
    s_mov_b32 s9, 28672
    buffer_load_dwordx4 v[144:147], v4, s[52:55], s9 offen offset:0
    buffer_load_dwordx4 v[148:151], v4, s[52:55], s9 offen offset:1024
    buffer_load_dwordx4 v[152:155], v4, s[52:55], s9 offen offset:2048
    buffer_load_dwordx4 v[156:159], v4, s[52:55], s9 offen offset:3072
    ds_read_b64_tr_b16 v[80:81], v12 offset:0
    ds_read_b64_tr_b16 v[82:83], v12 offset:512
    ds_read_b64_tr_b16 v[84:85], v12 offset:256
    ds_read_b64_tr_b16 v[86:87], v12 offset:768
    ds_read_b64_tr_b16 v[88:89], v12 offset:2048
    ds_read_b64_tr_b16 v[90:91], v12 offset:2560
    ds_read_b64_tr_b16 v[92:93], v12 offset:2304
    ds_read_b64_tr_b16 v[94:95], v12 offset:2816
    s_waitcnt lgkmcnt(4)
    v_mfma_f32_32x32x16_bf16 v[48:63], v[96:99], v[80:83], v[48:63]
    v_mfma_f32_32x32x16_bf16 v[64:79], v[96:99], v[84:87], v[64:79]
    ds_read_b64_tr_b16 v[80:81], v12 offset:4096
    ds_read_b64_tr_b16 v[82:83], v12 offset:4608
    ds_read_b64_tr_b16 v[84:85], v12 offset:4352
    ds_read_b64_tr_b16 v[86:87], v12 offset:4864
    s_waitcnt lgkmcnt(4)
    v_mfma_f32_32x32x16_bf16 v[48:63], v[100:103], v[88:91], v[48:63]
    v_mfma_f32_32x32x16_bf16 v[64:79], v[100:103], v[92:95], v[64:79]
    ds_read_b64_tr_b16 v[88:89], v12 offset:6144
    ds_read_b64_tr_b16 v[90:91], v12 offset:6656
    ds_read_b64_tr_b16 v[92:93], v12 offset:6400
    ds_read_b64_tr_b16 v[94:95], v12 offset:6912
    s_waitcnt lgkmcnt(4)
    v_mfma_f32_32x32x16_bf16 v[48:63], v[104:107], v[80:83], v[48:63]
    v_mfma_f32_32x32x16_bf16 v[64:79], v[104:107], v[84:87], v[64:79]
    s_waitcnt lgkmcnt(0)
    v_mfma_f32_32x32x16_bf16 v[48:63], v[108:111], v[88:91], v[48:63]
    v_mfma_f32_32x32x16_bf16 v[64:79], v[108:111], v[92:95], v[64:79]
    s_waitcnt vmcnt(22)
    s_barrier
    s_add_u32 m0, s14, 0
    s_mov_b32 s8, 65536
    buffer_load_dwordx4 v5, s[52:55], s8 offen lds
    s_add_u32 m0, s14, 1024
    s_mov_b32 s8, 65536
    buffer_load_dwordx4 v6, s[52:55], s8 offen lds
    s_add_u32 m0, s14, 2048
    s_mov_b32 s8, 65536
    buffer_load_dwordx4 v7, s[52:55], s8 offen lds
    s_add_u32 m0, s14, 3072
    s_mov_b32 s8, 65536
    buffer_load_dwordx4 v8, s[52:55], s8 offen lds
    s_mov_b32 s9, 32768
    buffer_load_dwordx4 v[96:99], v4, s[52:55], s9 offen offset:0
    buffer_load_dwordx4 v[100:103], v4, s[52:55], s9 offen offset:1024
    buffer_load_dwordx4 v[104:107], v4, s[52:55], s9 offen offset:2048
    buffer_load_dwordx4 v[108:111], v4, s[52:55], s9 offen offset:3072
    ds_read_b64_tr_b16 v[80:81], v12 offset:16384
    ds_read_b64_tr_b16 v[82:83], v12 offset:16896
    ds_read_b64_tr_b16 v[84:85], v12 offset:16640
    ds_read_b64_tr_b16 v[86:87], v12 offset:17152
    ds_read_b64_tr_b16 v[88:89], v12 offset:18432
    ds_read_b64_tr_b16 v[90:91], v12 offset:18944
    ds_read_b64_tr_b16 v[92:93], v12 offset:18688
    ds_read_b64_tr_b16 v[94:95], v12 offset:19200
    s_waitcnt lgkmcnt(4)
    v_mfma_f32_32x32x16_bf16 v[48:63], v[112:115], v[80:83], v[48:63]
    v_mfma_f32_32x32x16_bf16 v[64:79], v[112:115], v[84:87], v[64:79]
    ds_read_b64_tr_b16 v[80:81], v12 offset:20480
    ds_read_b64_tr_b16 v[82:83], v12 offset:20992
    ds_read_b64_tr_b16 v[84:85], v12 offset:20736
    ds_read_b64_tr_b16 v[86:87], v12 offset:21248
    s_waitcnt lgkmcnt(4)
    v_mfma_f32_32x32x16_bf16 v[48:63], v[116:119], v[88:91], v[48:63]
    v_mfma_f32_32x32x16_bf16 v[64:79], v[116:119], v[92:95], v[64:79]
    ds_read_b64_tr_b16 v[88:89], v12 offset:22528
    ds_read_b64_tr_b16 v[90:91], v12 offset:23040
    ds_read_b64_tr_b16 v[92:93], v12 offset:22784
    ds_read_b64_tr_b16 v[94:95], v12 offset:23296
    s_waitcnt lgkmcnt(4)
    v_mfma_f32_32x32x16_bf16 v[48:63], v[120:123], v[80:83], v[48:63]
    v_mfma_f32_32x32x16_bf16 v[64:79], v[120:123], v[84:87], v[64:79]
    s_waitcnt lgkmcnt(0)
    v_mfma_f32_32x32x16_bf16 v[48:63], v[124:127], v[88:91], v[48:63]
    v_mfma_f32_32x32x16_bf16 v[64:79], v[124:127], v[92:95], v[64:79]
    s_waitcnt vmcnt(16)
    s_barrier
    s_add_u32 m0, s14, 16384
    s_mov_b32 s8, 73728
    buffer_load_dwordx4 v5, s[52:55], s8 offen lds
    s_add_u32 m0, s14, 17408
    s_mov_b32 s8, 73728
    buffer_load_dwordx4 v6, s[52:55], s8 offen lds
    s_add_u32 m0, s14, 18432
    s_mov_b32 s8, 73728
    buffer_load_dwordx4 v7, s[52:55], s8 offen lds
    s_add_u32 m0, s14, 19456
    s_mov_b32 s8, 73728
    buffer_load_dwordx4 v8, s[52:55], s8 offen lds
    s_mov_b32 s9, 36864
    buffer_load_dwordx4 v[112:115], v4, s[52:55], s9 offen offset:0
    buffer_load_dwordx4 v[116:119], v4, s[52:55], s9 offen offset:1024
    buffer_load_dwordx4 v[120:123], v4, s[52:55], s9 offen offset:2048
    buffer_load_dwordx4 v[124:127], v4, s[52:55], s9 offen offset:3072
    ds_read_b64_tr_b16 v[80:81], v12 offset:32768
    ds_read_b64_tr_b16 v[82:83], v12 offset:33280
    ds_read_b64_tr_b16 v[84:85], v12 offset:33024
    ds_read_b64_tr_b16 v[86:87], v12 offset:33536
    ds_read_b64_tr_b16 v[88:89], v12 offset:34816
    ds_read_b64_tr_b16 v[90:91], v12 offset:35328
    ds_read_b64_tr_b16 v[92:93], v12 offset:35072
    ds_read_b64_tr_b16 v[94:95], v12 offset:35584
    s_waitcnt lgkmcnt(4)
    v_mfma_f32_32x32x16_bf16 v[48:63], v[128:131], v[80:83], v[48:63]
    v_lshlrev_b32 v160, 16, v32
    v_and_b32 v161, 0xffff0000, v32
    v_pk_mul_f32 v[160:161], v[160:161], v[16:17]
    v_sub_f32 v16, 1.0, v16
    v_sub_f32 v17, 1.0, v17
    v_cvt_pk_bf16_f32 v32, v160, v161
    v_mfma_f32_32x32x16_bf16 v[64:79], v[128:131], v[84:87], v[64:79]
    v_cvt_pk_bf16_f32 v17, v16, v17
    v_lshlrev_b32 v160, 16, v32
    v_and_b32 v161, 0xffff0000, v32
    v_lshlrev_b32 v16, 16, v17
    v_and_b32 v17, 0xffff0000, v17
    v_lshlrev_b32 v162, 16, v33
    ds_read_b64_tr_b16 v[80:81], v12 offset:36864
    ds_read_b64_tr_b16 v[82:83], v12 offset:37376
    ds_read_b64_tr_b16 v[84:85], v12 offset:37120
    ds_read_b64_tr_b16 v[86:87], v12 offset:37632
    s_waitcnt lgkmcnt(4)
    v_mfma_f32_32x32x16_bf16 v[48:63], v[132:135], v[88:91], v[48:63]
    v_and_b32 v163, 0xffff0000, v33
    v_pk_mul_f32 v[162:163], v[162:163], v[18:19]
    v_sub_f32 v18, 1.0, v18
    v_sub_f32 v19, 1.0, v19
    v_cvt_pk_bf16_f32 v33, v162, v163
    v_cvt_pk_bf16_f32 v19, v18, v19
    v_mfma_f32_32x32x16_bf16 v[64:79], v[132:135], v[92:95], v[64:79]
    v_lshlrev_b32 v162, 16, v33
    v_and_b32 v163, 0xffff0000, v33
    v_lshlrev_b32 v18, 16, v19
    v_and_b32 v19, 0xffff0000, v19
    v_lshlrev_b32 v164, 16, v34
    v_and_b32 v165, 0xffff0000, v34
    ds_read_b64_tr_b16 v[88:89], v12 offset:38912
    ds_read_b64_tr_b16 v[90:91], v12 offset:39424
    ds_read_b64_tr_b16 v[92:93], v12 offset:39168
    ds_read_b64_tr_b16 v[94:95], v12 offset:39680
    s_waitcnt lgkmcnt(4)
    v_mfma_f32_32x32x16_bf16 v[48:63], v[136:139], v[80:83], v[48:63]
    v_pk_mul_f32 v[164:165], v[164:165], v[20:21]
    v_sub_f32 v20, 1.0, v20
    v_sub_f32 v21, 1.0, v21
    v_cvt_pk_bf16_f32 v34, v164, v165
    v_cvt_pk_bf16_f32 v21, v20, v21
    v_lshlrev_b32 v164, 16, v34
    v_mfma_f32_32x32x16_bf16 v[64:79], v[136:139], v[84:87], v[64:79]
    v_and_b32 v165, 0xffff0000, v34
    v_lshlrev_b32 v20, 16, v21
    v_and_b32 v21, 0xffff0000, v21
    v_lshlrev_b32 v166, 16, v35
    v_and_b32 v167, 0xffff0000, v35
    v_pk_mul_f32 v[166:167], v[166:167], v[22:23]
    s_waitcnt lgkmcnt(0)
    v_mfma_f32_32x32x16_bf16 v[48:63], v[140:143], v[88:91], v[48:63]
    v_sub_f32 v22, 1.0, v22
    v_sub_f32 v23, 1.0, v23
    v_cvt_pk_bf16_f32 v35, v166, v167
    v_cvt_pk_bf16_f32 v23, v22, v23
    v_lshlrev_b32 v166, 16, v35
    v_and_b32 v167, 0xffff0000, v35
    v_mfma_f32_32x32x16_bf16 v[64:79], v[140:143], v[92:95], v[64:79]
    v_lshlrev_b32 v22, 16, v23
    v_and_b32 v23, 0xffff0000, v23
    v_lshlrev_b32 v168, 16, v36
    v_and_b32 v169, 0xffff0000, v36
    v_pk_mul_f32 v[168:169], v[168:169], v[24:25]
    v_sub_f32 v24, 1.0, v24
    s_waitcnt vmcnt(16)
    s_barrier
    s_add_u32 m0, s14, 32768
    s_mov_b32 s8, 81920
    buffer_load_dwordx4 v5, s[52:55], s8 offen lds
    s_add_u32 m0, s14, 33792
    s_mov_b32 s8, 81920
    buffer_load_dwordx4 v6, s[52:55], s8 offen lds
    s_add_u32 m0, s14, 34816
    s_mov_b32 s8, 81920
    buffer_load_dwordx4 v7, s[52:55], s8 offen lds
    s_add_u32 m0, s14, 35840
    s_mov_b32 s8, 81920
    buffer_load_dwordx4 v8, s[52:55], s8 offen lds
    s_mov_b32 s9, 40960
    buffer_load_dwordx4 v[128:131], v4, s[52:55], s9 offen offset:0
    buffer_load_dwordx4 v[132:135], v4, s[52:55], s9 offen offset:1024
    buffer_load_dwordx4 v[136:139], v4, s[52:55], s9 offen offset:2048
    ds_read_b64_tr_b16 v[80:81], v12 offset:49152
    ds_read_b64_tr_b16 v[82:83], v12 offset:49664
    ds_read_b64_tr_b16 v[84:85], v12 offset:49408
    ds_read_b64_tr_b16 v[86:87], v12 offset:49920
    ds_read_b64_tr_b16 v[88:89], v12 offset:51200
    ds_read_b64_tr_b16 v[90:91], v12 offset:51712
    ds_read_b64_tr_b16 v[92:93], v12 offset:51456
    ds_read_b64_tr_b16 v[94:95], v12 offset:51968
    s_waitcnt lgkmcnt(4)
    v_mfma_f32_32x32x16_bf16 v[48:63], v[144:147], v[80:83], v[48:63]
    v_sub_f32 v25, 1.0, v25
    v_cvt_pk_bf16_f32 v36, v168, v169
    v_cvt_pk_bf16_f32 v25, v24, v25
    v_lshlrev_b32 v168, 16, v36
    v_and_b32 v169, 0xffff0000, v36
    v_lshlrev_b32 v24, 16, v25
    v_mfma_f32_32x32x16_bf16 v[64:79], v[144:147], v[84:87], v[64:79]
    v_and_b32 v25, 0xffff0000, v25
    v_lshlrev_b32 v170, 16, v37
    v_and_b32 v171, 0xffff0000, v37
    v_pk_mul_f32 v[170:171], v[170:171], v[26:27]
    v_sub_f32 v26, 1.0, v26
    v_sub_f32 v27, 1.0, v27
    ds_read_b64_tr_b16 v[80:81], v12 offset:53248
    ds_read_b64_tr_b16 v[82:83], v12 offset:53760
    ds_read_b64_tr_b16 v[84:85], v12 offset:53504
    ds_read_b64_tr_b16 v[86:87], v12 offset:54016
    s_waitcnt lgkmcnt(4)
    v_mfma_f32_32x32x16_bf16 v[48:63], v[148:151], v[88:91], v[48:63]
    v_cvt_pk_bf16_f32 v37, v170, v171
    v_cvt_pk_bf16_f32 v27, v26, v27
    v_lshlrev_b32 v170, 16, v37
    v_and_b32 v171, 0xffff0000, v37
    v_lshlrev_b32 v26, 16, v27
    v_and_b32 v27, 0xffff0000, v27
    v_mfma_f32_32x32x16_bf16 v[64:79], v[148:151], v[92:95], v[64:79]
    v_lshlrev_b32 v172, 16, v38
    v_and_b32 v173, 0xffff0000, v38
    v_pk_mul_f32 v[172:173], v[172:173], v[28:29]
    v_sub_f32 v28, 1.0, v28
    v_sub_f32 v29, 1.0, v29
    v_cvt_pk_bf16_f32 v38, v172, v173
    ds_read_b64_tr_b16 v[88:89], v12 offset:55296
    ds_read_b64_tr_b16 v[90:91], v12 offset:55808
    ds_read_b64_tr_b16 v[92:93], v12 offset:55552
    ds_read_b64_tr_b16 v[94:95], v12 offset:56064
    s_waitcnt lgkmcnt(4)
    v_mfma_f32_32x32x16_bf16 v[48:63], v[152:155], v[80:83], v[48:63]
    v_cvt_pk_bf16_f32 v29, v28, v29
    v_lshlrev_b32 v172, 16, v38
    v_and_b32 v173, 0xffff0000, v38
    v_lshlrev_b32 v28, 16, v29
    v_and_b32 v29, 0xffff0000, v29
    v_lshlrev_b32 v174, 16, v39
    v_mfma_f32_32x32x16_bf16 v[64:79], v[152:155], v[84:87], v[64:79]
    v_and_b32 v175, 0xffff0000, v39
    v_pk_mul_f32 v[174:175], v[174:175], v[30:31]
    v_sub_f32 v30, 1.0, v30
    v_sub_f32 v31, 1.0, v31
    v_cvt_pk_bf16_f32 v39, v174, v175
    v_cvt_pk_bf16_f32 v31, v30, v31
    s_waitcnt lgkmcnt(0)
    v_mfma_f32_32x32x16_bf16 v[48:63], v[156:159], v[88:91], v[48:63]
    v_lshlrev_b32 v174, 16, v39
    v_and_b32 v175, 0xffff0000, v39
    v_lshlrev_b32 v30, 16, v31
    v_and_b32 v31, 0xffff0000, v31
    v_mfma_f32_32x32x16_bf16 v[64:79], v[156:159], v[92:95], v[64:79]
    s_waitcnt vmcnt(15)
    s_barrier
    ds_read_b64_tr_b16 v[80:81], v12 offset:0
    ds_read_b64_tr_b16 v[82:83], v12 offset:512
    ds_read_b64_tr_b16 v[84:85], v12 offset:256
    ds_read_b64_tr_b16 v[86:87], v12 offset:768
    ds_read_b64_tr_b16 v[88:89], v12 offset:2048
    ds_read_b64_tr_b16 v[90:91], v12 offset:2560
    ds_read_b64_tr_b16 v[92:93], v12 offset:2304
    ds_read_b64_tr_b16 v[94:95], v12 offset:2816
    s_waitcnt lgkmcnt(4)
    v_mfma_f32_32x32x16_bf16 v[48:63], v[96:99], v[80:83], v[48:63]
    v_mfma_f32_32x32x16_bf16 v[64:79], v[96:99], v[84:87], v[64:79]
    ds_read_b64_tr_b16 v[80:81], v12 offset:4096
    ds_read_b64_tr_b16 v[82:83], v12 offset:4608
    ds_read_b64_tr_b16 v[84:85], v12 offset:4352
    ds_read_b64_tr_b16 v[86:87], v12 offset:4864
    s_waitcnt lgkmcnt(4)
    v_mfma_f32_32x32x16_bf16 v[48:63], v[100:103], v[88:91], v[48:63]
    v_mfma_f32_32x32x16_bf16 v[64:79], v[100:103], v[92:95], v[64:79]
    ds_read_b64_tr_b16 v[88:89], v12 offset:6144
    ds_read_b64_tr_b16 v[90:91], v12 offset:6656
    ds_read_b64_tr_b16 v[92:93], v12 offset:6400
    ds_read_b64_tr_b16 v[94:95], v12 offset:6912
    s_waitcnt lgkmcnt(4)
    v_mfma_f32_32x32x16_bf16 v[48:63], v[104:107], v[80:83], v[48:63]
    v_mfma_f32_32x32x16_bf16 v[64:79], v[104:107], v[84:87], v[64:79]
    s_waitcnt lgkmcnt(0)
    v_mfma_f32_32x32x16_bf16 v[48:63], v[108:111], v[88:91], v[48:63]
    v_mfma_f32_32x32x16_bf16 v[64:79], v[108:111], v[92:95], v[64:79]
    s_waitcnt vmcnt(7)
    s_barrier
    ds_read_b64_tr_b16 v[80:81], v12 offset:16384
    ds_read_b64_tr_b16 v[82:83], v12 offset:16896
    ds_read_b64_tr_b16 v[84:85], v12 offset:16640
    ds_read_b64_tr_b16 v[86:87], v12 offset:17152
    ds_read_b64_tr_b16 v[88:89], v12 offset:18432
    ds_read_b64_tr_b16 v[90:91], v12 offset:18944
    ds_read_b64_tr_b16 v[92:93], v12 offset:18688
    ds_read_b64_tr_b16 v[94:95], v12 offset:19200
    s_waitcnt lgkmcnt(4)
    v_mfma_f32_32x32x16_bf16 v[48:63], v[112:115], v[80:83], v[48:63]
    v_mfma_f32_32x32x16_bf16 v[64:79], v[112:115], v[84:87], v[64:79]
    ds_read_b64_tr_b16 v[80:81], v12 offset:20480
    ds_read_b64_tr_b16 v[82:83], v12 offset:20992
    ds_read_b64_tr_b16 v[84:85], v12 offset:20736
    ds_read_b64_tr_b16 v[86:87], v12 offset:21248
    s_waitcnt lgkmcnt(4)
    v_mfma_f32_32x32x16_bf16 v[48:63], v[116:119], v[88:91], v[48:63]
    v_mfma_f32_32x32x16_bf16 v[64:79], v[116:119], v[92:95], v[64:79]
    ds_read_b64_tr_b16 v[88:89], v12 offset:22528
    ds_read_b64_tr_b16 v[90:91], v12 offset:23040
    ds_read_b64_tr_b16 v[92:93], v12 offset:22784
    ds_read_b64_tr_b16 v[94:95], v12 offset:23296
    s_waitcnt lgkmcnt(4)
    v_mfma_f32_32x32x16_bf16 v[48:63], v[120:123], v[80:83], v[48:63]
    v_mfma_f32_32x32x16_bf16 v[64:79], v[120:123], v[84:87], v[64:79]
    s_waitcnt lgkmcnt(0)
    v_mfma_f32_32x32x16_bf16 v[48:63], v[124:127], v[88:91], v[48:63]
    v_mfma_f32_32x32x16_bf16 v[64:79], v[124:127], v[92:95], v[64:79]
    s_waitcnt vmcnt(0)
    s_barrier
    ds_read_b64_tr_b16 v[80:81], v12 offset:32768
    ds_read_b64_tr_b16 v[82:83], v12 offset:33280
    ds_read_b64_tr_b16 v[84:85], v12 offset:33024
    ds_read_b64_tr_b16 v[86:87], v12 offset:33536
    ds_read_b64_tr_b16 v[88:89], v12 offset:34816
    ds_read_b64_tr_b16 v[90:91], v12 offset:35328
    ds_read_b64_tr_b16 v[92:93], v12 offset:35072
    ds_read_b64_tr_b16 v[94:95], v12 offset:35584
    s_waitcnt lgkmcnt(4)
    v_mfma_f32_32x32x16_bf16 v[48:63], v[128:131], v[80:83], v[48:63]
    v_mfma_f32_32x32x16_bf16 v[64:79], v[128:131], v[84:87], v[64:79]
    ds_read_b64_tr_b16 v[80:81], v12 offset:36864
    ds_read_b64_tr_b16 v[82:83], v12 offset:37376
    ds_read_b64_tr_b16 v[84:85], v12 offset:37120
    ds_read_b64_tr_b16 v[86:87], v12 offset:37632
    s_waitcnt lgkmcnt(4)
    v_mfma_f32_32x32x16_bf16 v[48:63], v[132:135], v[88:91], v[48:63]
    v_mfma_f32_32x32x16_bf16 v[64:79], v[132:135], v[92:95], v[64:79]
    s_waitcnt lgkmcnt(0)
    v_mfma_f32_32x32x16_bf16 v[48:63], v[136:139], v[80:83], v[48:63]
    v_mfma_f32_32x32x16_bf16 v[64:79], v[136:139], v[84:87], v[64:79]
    s_barrier
    s_lshl_b32 s10, s7, 12
    v_lshlrev_b32 v4, 4, v1
    v_add_u32 v5, s10, v4
    s_xor_b32 s11, s10, 0x2000
    v_add_u32 v6, s11, v4
    s_cmp_eq_u32 s13, 0
    s_nop 4
    s_cbranch_scc0 L_k2_w1
    ds_write_b128 v5, v[64:67] offset:0
    ds_write_b128 v5, v[68:71] offset:1024
    ds_write_b128 v5, v[72:75] offset:2048
    ds_write_b128 v5, v[76:79] offset:3072
    s_branch L_k2_wd
L_k2_w1:
    ds_write_b128 v5, v[48:51] offset:0
    ds_write_b128 v5, v[52:55] offset:1024
    ds_write_b128 v5, v[56:59] offset:2048
    ds_write_b128 v5, v[60:63] offset:3072
    v_mov_b32 v48, v64
    v_mov_b32 v49, v65
    v_mov_b32 v50, v66
    v_mov_b32 v51, v67
    v_mov_b32 v52, v68
    v_mov_b32 v53, v69
    v_mov_b32 v54, v70
    v_mov_b32 v55, v71
    v_mov_b32 v56, v72
    v_mov_b32 v57, v73
    v_mov_b32 v58, v74
    v_mov_b32 v59, v75
    v_mov_b32 v60, v76
    v_mov_b32 v61, v77
    v_mov_b32 v62, v78
    v_mov_b32 v63, v79
L_k2_wd:
    s_waitcnt lgkmcnt(0)
    s_barrier
    ds_read_b128 v[96:99], v6 offset:0
    ds_read_b128 v[100:103], v6 offset:1024
    ds_read_b128 v[104:107], v6 offset:2048
    ds_read_b128 v[108:111], v6 offset:3072
    v_lshlrev_b32 v8, 12, v3
    v_lshl_add_u32 v8, v10, 1, v8
    s_lshl_b32 s10, s15, 10
    v_add_u32 v8, s10, v8
    v_add_u32 v12, 0x2000, v8
    v_add_u32 v13, 0x4000, v8
    v_add_u32 v14, 0x6000, v8
    s_waitcnt vmcnt(0) lgkmcnt(0)
    v_pk_add_f32 v[112:113], v[48:49], v[96:97]
    v_cvt_pk_bf16_f32 v114, v112, v113
    v_lshlrev_b32 v112, 16, v114
    v_and_b32 v113, 0xffff0000, v114
    v_pk_mul_f32 v[112:113], v[112:113], v[16:17]
    v_cvt_pk_bf16_f32 v114, v112, v113
    v_lshlrev_b32 v112, 16, v114
    v_and_b32 v113, 0xffff0000, v114
    v_pk_add_f32 v[112:113], v[112:113], v[160:161]
    v_cvt_pk_bf16_f32 v118, v112, v113
    buffer_store_short v118, v8, s[60:63], 0 offen offset:0 sc0 sc1
    buffer_store_short_d16_hi v118, v8, s[60:63], 0 offen offset:1024 sc0 sc1
    v_pk_add_f32 v[112:113], v[50:51], v[98:99]
    v_cvt_pk_bf16_f32 v114, v112, v113
    v_lshlrev_b32 v112, 16, v114
    v_and_b32 v113, 0xffff0000, v114
    v_pk_mul_f32 v[112:113], v[112:113], v[18:19]
    v_cvt_pk_bf16_f32 v114, v112, v113
    v_lshlrev_b32 v112, 16, v114
    v_and_b32 v113, 0xffff0000, v114
    v_pk_add_f32 v[112:113], v[112:113], v[162:163]
    v_cvt_pk_bf16_f32 v119, v112, v113
    buffer_store_short v119, v8, s[60:63], 0 offen offset:2048 sc0 sc1
    buffer_store_short_d16_hi v119, v8, s[60:63], 0 offen offset:3072 sc0 sc1
    v_pk_add_f32 v[112:113], v[52:53], v[100:101]
    v_cvt_pk_bf16_f32 v114, v112, v113
    v_lshlrev_b32 v112, 16, v114
    v_and_b32 v113, 0xffff0000, v114
    v_pk_mul_f32 v[112:113], v[112:113], v[20:21]
    v_cvt_pk_bf16_f32 v114, v112, v113
    v_lshlrev_b32 v112, 16, v114
    v_and_b32 v113, 0xffff0000, v114
    v_pk_add_f32 v[112:113], v[112:113], v[164:165]
    v_cvt_pk_bf16_f32 v118, v112, v113
    buffer_store_short v118, v12, s[60:63], 0 offen offset:0 sc0 sc1
    buffer_store_short_d16_hi v118, v12, s[60:63], 0 offen offset:1024 sc0 sc1
    v_pk_add_f32 v[112:113], v[54:55], v[102:103]
    v_cvt_pk_bf16_f32 v114, v112, v113
    v_lshlrev_b32 v112, 16, v114
    v_and_b32 v113, 0xffff0000, v114
    v_pk_mul_f32 v[112:113], v[112:113], v[22:23]
    v_cvt_pk_bf16_f32 v114, v112, v113
    v_lshlrev_b32 v112, 16, v114
    v_and_b32 v113, 0xffff0000, v114
    v_pk_add_f32 v[112:113], v[112:113], v[166:167]
    v_cvt_pk_bf16_f32 v119, v112, v113
    buffer_store_short v119, v12, s[60:63], 0 offen offset:2048 sc0 sc1
    buffer_store_short_d16_hi v119, v12, s[60:63], 0 offen offset:3072 sc0 sc1
    v_pk_add_f32 v[112:113], v[56:57], v[104:105]
    v_cvt_pk_bf16_f32 v114, v112, v113
    v_lshlrev_b32 v112, 16, v114
    v_and_b32 v113, 0xffff0000, v114
    v_pk_mul_f32 v[112:113], v[112:113], v[24:25]
    v_cvt_pk_bf16_f32 v114, v112, v113
    v_lshlrev_b32 v112, 16, v114
    v_and_b32 v113, 0xffff0000, v114
    v_pk_add_f32 v[112:113], v[112:113], v[168:169]
    v_cvt_pk_bf16_f32 v118, v112, v113
    buffer_store_short v118, v13, s[60:63], 0 offen offset:0 sc0 sc1
    buffer_store_short_d16_hi v118, v13, s[60:63], 0 offen offset:1024 sc0 sc1
    v_pk_add_f32 v[112:113], v[58:59], v[106:107]
    v_cvt_pk_bf16_f32 v114, v112, v113
    v_lshlrev_b32 v112, 16, v114
    v_and_b32 v113, 0xffff0000, v114
    v_pk_mul_f32 v[112:113], v[112:113], v[26:27]
    v_cvt_pk_bf16_f32 v114, v112, v113
    v_lshlrev_b32 v112, 16, v114
    v_and_b32 v113, 0xffff0000, v114
    v_pk_add_f32 v[112:113], v[112:113], v[170:171]
    v_cvt_pk_bf16_f32 v119, v112, v113
    buffer_store_short v119, v13, s[60:63], 0 offen offset:2048 sc0 sc1
    buffer_store_short_d16_hi v119, v13, s[60:63], 0 offen offset:3072 sc0 sc1
    v_pk_add_f32 v[112:113], v[60:61], v[108:109]
    v_cvt_pk_bf16_f32 v114, v112, v113
    v_lshlrev_b32 v112, 16, v114
    v_and_b32 v113, 0xffff0000, v114
    v_pk_mul_f32 v[112:113], v[112:113], v[28:29]
    v_cvt_pk_bf16_f32 v114, v112, v113
    v_lshlrev_b32 v112, 16, v114
    v_and_b32 v113, 0xffff0000, v114
    v_pk_add_f32 v[112:113], v[112:113], v[172:173]
    v_cvt_pk_bf16_f32 v118, v112, v113
    buffer_store_short v118, v14, s[60:63], 0 offen offset:0 sc0 sc1
    buffer_store_short_d16_hi v118, v14, s[60:63], 0 offen offset:1024 sc0 sc1
    v_pk_add_f32 v[112:113], v[62:63], v[110:111]
    v_cvt_pk_bf16_f32 v114, v112, v113
    v_lshlrev_b32 v112, 16, v114
    v_and_b32 v113, 0xffff0000, v114
    v_pk_mul_f32 v[112:113], v[112:113], v[30:31]
    v_cvt_pk_bf16_f32 v114, v112, v113
    v_lshlrev_b32 v112, 16, v114
    v_and_b32 v113, 0xffff0000, v114
    v_pk_add_f32 v[112:113], v[112:113], v[174:175]
    v_cvt_pk_bf16_f32 v119, v112, v113
    buffer_store_short v119, v14, s[60:63], 0 offen offset:2048 sc0 sc1
    buffer_store_short_d16_hi v119, v14, s[60:63], 0 offen offset:3072 sc0 sc1
L_k2_exit:
    s_endpgm

.section .rodata,"a"
.p2align 6
.amdhsa_kernel gated_mix__ssm_conv_s4d__geglu_ffn__prompt_kernel
  .amdhsa_next_free_vgpr 224
  .amdhsa_next_free_sgpr 75
  .amdhsa_accum_offset 224
  .amdhsa_group_segment_fixed_size 0
  .amdhsa_kernarg_size 120
  .amdhsa_user_sgpr_count 2
  .amdhsa_user_sgpr_kernarg_segment_ptr 1
  .amdhsa_system_sgpr_workgroup_id_x 1
.end_amdhsa_kernel

.p2align 6
.amdhsa_kernel gm_stage2_kernel
  .amdhsa_next_free_vgpr 176
  .amdhsa_next_free_sgpr 79
  .amdhsa_accum_offset 176
  .amdhsa_group_segment_fixed_size 0
  .amdhsa_kernarg_size 120
  .amdhsa_user_sgpr_count 2
  .amdhsa_user_sgpr_kernarg_segment_ptr 1
  .amdhsa_system_sgpr_workgroup_id_x 1
.end_amdhsa_kernel
```
